```python
import torch

def _softmax(x, axis=-1):
    return torch.softmax(x, dim=axis)
def _gelu(x):
    return torch.nn.functional.gelu(x, approximate="tanh")
def _silu(x):
    return torch.nn.functional.silu(x)
def _sigmoid(x):
    return torch.sigmoid(x)
def _layernorm(x, axis=-1, eps=1e-5):
    m = x.mean(dim=axis, keepdim=True)
    v = x.var(dim=axis, keepdim=True, unbiased=False)
    return (x - m) / torch.sqrt(v + eps)
def _scatter_add(tgt, idx, src, axis=0):
    return tgt.clone().index_add_(axis, idx, src)
def _segment_sum(src, seg, n):
    out = torch.zeros((n,) + src.shape[1:], dtype=src.dtype)
    return out.index_add_(0, seg, src)
def _pad(x, pw):
    flat = tuple(v for pair in reversed(pw) for v in pair)
    return torch.nn.functional.pad(x, flat)

kernel_name = 'standalone__w4a16_gemm_dequant__prompt'

def setup_inputs():

    _w = (lambda a: (lambda t: t.to(torch.bfloat16) if t.is_floating_point() else t)(torch.as_tensor(a)))
    B, S, D, F = 1, 2048, 576, 4608
    G = 32 if 32 > 0 else D
    D = (D // G) * G
    ng = D // G
    qw = torch.randint(0, 16, (D, F)).to(torch.int32)
    return {
        "x": _w((lambda *s: torch.randn(*s, dtype=torch.bfloat16) * 0.05)(B, S, D)),
        "qw": _w(qw),
        "scales": _w(torch.abs((lambda *s: torch.randn(*s, dtype=torch.bfloat16) * 0.05)(ng, F)) + 0.01),
        "zeros": _w(torch.full((ng, F), 8.0, dtype=float)),
    }

def reference(x, qw, scales, zeros):
    B, S, D = x.shape
    ng, F = scales.shape
    G = D // ng
    s = (lambda x, n, axis: torch.repeat_interleave(x, n, dim=axis))(scales, G, axis=0)
    z = (lambda x, n, axis: torch.repeat_interleave(x, n, dim=axis))(zeros, G, axis=0)
    w = ((lambda x, dt: x.to(dt))(qw, x.dtype) - z) * s
    return x @ w
```

```asm
; @launch grid=(256,1,1) block=(512,1,1) lds=163840
.amdgcn_target "amdgcn-amd-amdhsa--gfx950"
.text
.globl standalone__w4a16_gemm_dequant__prompt_kernel
.p2align 8
.type standalone__w4a16_gemm_dequant__prompt_kernel,@function
standalone__w4a16_gemm_dequant__prompt_kernel:
    s_cmp_ge_u32 s2, 256
    s_cbranch_scc1 L_done
    s_load_dwordx2 s[20:21], s[0:1], 8
    s_load_dwordx2 s[24:25], s[0:1], 16
    s_load_dwordx2 s[28:29], s[0:1], 24
    s_load_dwordx2 s[16:17], s[0:1], 0
    s_load_dwordx2 s[32:33], s[0:1], 32
    v_lshrrev_b32 v1, 6, v0
    s_and_b32 s3, s2, 1
    s_lshl_b32 s3, s3, 5
    s_lshr_b32 s98, s2, 3
    s_add_u32 s3, s3, s98
    v_readfirstlane_b32 s56, v1
    s_cmp_eq_u32 s3, 63
    s_cbranch_scc1 L_done
    v_and_b32 v20, 63, v0
    s_mul_i32 s13, s3, 37
    s_lshr_b32 s13, s13, 8
    v_lshrrev_b32 v23, 3, v20
    s_mul_i32 s15, s13, 7
    s_sub_u32 s15, s3, s15
    v_mul_u32_u24 v23, 73728, v23
    s_bfe_u32 s3, s2, 0x20001
    s_mul_i32 s3, s3, 9
    s_add_u32 s3, s3, s13
    v_and_b32 v24, 7, v0
    s_lshl_b32 s101, s15, 2
    s_lshr_b32 s101, 0x6440088, s101
    s_and_b32 s101, s101, 15
    v_lshl_add_u32 v23, v24, 4, v23
    s_and_b32 s100, s2, 7
    s_lshl_b32 s100, s100, 2
    s_lshr_b32 s100, 0x76543210, s100
    s_and_b32 s100, s100, 15
    s_add_u32 s101, s101, s100
    s_sub_u32 s100, s101, 9
    s_min_u32 s101, s100, s101
    s_lshl_b32 s40, s101, 7
    s_lshr_b32 s100, s56, 2
    s_mul_i32 s57, s100, 589824
    s_lshl_b32 s58, s3, 9
    s_add_u32 s57, s57, s58
    s_and_b32 s58, s56, 3
    s_lshl_b32 s58, s58, 7
    s_add_u32 s57, s57, s58
    v_add_u32 v1, s57, v23
    s_mov_b32 s22, 10616832
    s_mov_b32 s23, 0x00020000
    v_add_u32 v109, 18432, v1
    v_add_u32 v110, 36864, v1
    v_add_u32 v111, 55296, v1
    v_lshrrev_b32 v23, 5, v0
    v_add_u32 v23, s101, v23
    v_subrev_u32 v24, 9, v23
    v_min_u32 v23, v23, v24
    v_bfe_u32 v24, v0, 4, 1
    v_lshl_add_u32 v23, v23, 1, v24
    v_mul_u32_u24 v23, 9216, v23
    v_and_b32 v24, 15, v0
    v_lshl_add_u32 v23, v24, 4, v23
    s_lshl_b32 s57, s3, 8
    v_add_u32 v14, s57, v23
    s_mov_b32 s26, 165888
    s_mov_b32 s27, 0x00020000
    s_mov_b32 s30, 165888
    s_mov_b32 s31, 0x00020000
    s_cmp_lg_u32 s100, 0
    s_cbranch_scc1 L_rh1
    s_waitcnt lgkmcnt(0)
    buffer_load_dwordx4 v[24:27], v14, s[24:27], 0 offen
    buffer_load_dwordx4 v[28:31], v14, s[28:31], 0 offen
    s_mul_i32 s59, s40, 9216
    buffer_load_dwordx4 v[112:115], v1, s[20:23], s59 offen
    buffer_load_dwordx4 v[116:119], v109, s[20:23], s59 offen
    buffer_load_dwordx4 v[120:123], v110, s[20:23], s59 offen
    buffer_load_dwordx4 v[124:127], v111, s[20:23], s59 offen
    s_cmp_lt_u32 s15, 2
    s_cselect_b32 s55, 19, 18
    v_and_b32 v21, 15, v0
    s_min_u32 s100, s15, 2
    s_mul_i32 s57, s15, 18
    s_add_u32 s100, s100, s57
    v_bfe_u32 v22, v0, 4, 2
    s_add_u32 s57, s100, s55
    s_mul_i32 s51, s57, 18432
    s_mul_i32 s52, s55, 18432
    s_and_b32 s98, s56, 1
    s_bfe_u32 s99, s56, 0x10001
    s_lshl_b32 s57, s98, 2
    v_add_u32 v16, s57, v22
    v_and_b32 v17, 7, v20
    v_xor_b32 v16, v16, v17
    s_sub_u32 s57, s13, 5
    s_cmp_ge_u32 s13, 5
    s_cselect_b32 s57, s57, s13
    s_mul_i32 s57, s57, 4
    s_add_u32 s100, s100, s57
    v_lshrrev_b32 v17, 3, v20
    v_mul_u32_u24 v17, 1152, v17
    v_lshl_add_u32 v2, v16, 4, v17
    s_mul_i32 s50, s100, 18432
    s_mul_i32 s57, s98, 9216
    v_add_u32 v2, s57, v2
    s_mul_i32 s57, s99, 18432
    s_add_u32 s53, s50, s57
    s_lshl_b32 s54, s56, 10
    s_and_b32 s54, s54, 0xc00
    s_mov_b32 s18, 2359296
    s_mov_b32 s19, 0x00020000
    s_add_u32 s60, s53, 0
    s_cmp_ge_u32 s60, s51
    s_cselect_b32 s58, s52, 0
    s_sub_u32 s60, s60, s58
    s_add_u32 m0, s54, 53248
    s_add_u32 s57, s60, s40
    buffer_load_dwordx4 v2, s[16:19], s57 offen lds
    s_add_u32 s62, s53, 73728
    s_cmp_ge_u32 s62, s51
    s_cselect_b32 s58, s52, 0
    s_sub_u32 s62, s62, s58
    s_add_u32 m0, s54, 61440
    s_add_u32 s57, s62, s40
    buffer_load_dwordx4 v2, s[16:19], s57 offen lds
    s_add_u32 s64, s53, 147456
    s_cmp_ge_u32 s64, s51
    s_cselect_b32 s58, s52, 0
    s_sub_u32 s64, s64, s58
    s_add_u32 m0, s54, 69632
    s_add_u32 s57, s64, s40
    buffer_load_dwordx4 v2, s[16:19], s57 offen lds
    s_add_u32 s41, s40, 128
    s_cmp_eq_u32 s41, 1152
    s_cselect_b32 s41, 0, s41
    s_add_u32 s42, s41, 128
    s_cmp_eq_u32 s42, 1152
    s_cselect_b32 s42, 0, s42
    s_add_u32 s43, s42, 128
    s_cmp_eq_u32 s43, 1152
    s_cselect_b32 s43, 0, s43
    s_add_u32 s44, s43, 128
    s_cmp_eq_u32 s44, 1152
    s_cselect_b32 s44, 0, s44
    s_add_u32 s45, s44, 128
    s_cmp_eq_u32 s45, 1152
    s_cselect_b32 s45, 0, s45
    s_add_u32 s46, s45, 128
    s_cmp_eq_u32 s46, 1152
    s_cselect_b32 s46, 0, s46
    s_add_u32 s47, s46, 128
    s_cmp_eq_u32 s47, 1152
    s_cselect_b32 s47, 0, s47
    s_add_u32 s48, s47, 128
    s_cmp_eq_u32 s48, 1152
    s_cselect_b32 s48, 0, s48
    s_mov_b32 s34, 18874368
    s_mov_b32 s35, 0x00020000
    v_lshrrev_b32 v16, 2, v20
    v_mul_u32_u24 v16, 9216, v16
    v_and_b32 v17, 3, v20
    v_lshl_add_u32 v16, v17, 4, v16
    s_lshr_b32 s57, s54, 4
    s_lshl_b32 s58, s3, 8
    s_add_u32 s57, s57, s58
    v_add_u32 v3, s57, v16
    v_bfe_u32 v16, v21, 2, 1
    v_and_b32 v17, 3, v21
    v_lshlrev_b32 v17, 1, v17
    v_lshrrev_b32 v18, 3, v21
    v_add_u32 v17, v17, v18
    v_lshlrev_b32 v17, 4, v17
    v_lshl_add_u32 v17, v16, 10, v17
    v_lshl_add_u32 v17, v22, 7, v17
    s_lshl_b32 s57, s54, 1
    v_add_u32 v4, s57, v17
    v_and_b32 v16, 7, v21
    v_lshlrev_b32 v16, 4, v16
    v_lshl_add_u32 v17, v18, 3, v16
    v_lshl_add_u32 v17, v22, 7, v17
    s_add_u32 s57, s57, 0
    v_add_u32 v5, s57, v17
    s_lshr_b32 s57, s54, 3
    s_add_u32 s57, s57, 0
    v_add_u32 v7, s57, v16
    v_lshrrev_b32 v16, 1, v21
    v_xor_b32 v16, v16, v22
    v_lshlrev_b32 v16, 4, v16
    v_lshl_add_u32 v8, v21, 7, v16
    v_xor_b32 v9, 64, v8
    v_add_u32 v10, 65536, v8
    v_add_u32 v11, 65536, v9
    v_add_u32 v12, 131072, v8
    v_add_u32 v13, 131072, v9
    v_lshrrev_b32 v16, 4, v0
    v_lshlrev_b32 v16, 10, v16
    v_lshl_add_u32 v15, v21, 5, v16
    s_mov_b32 s90, 0x00ff00ff
    s_mov_b32 s91, 0x00ff00ff
    s_not_b64 s[92:93], s[90:91]
    s_mov_b32 s94, 0x0f0f0f0f
    s_mov_b32 s95, 0x0f0f0f0f
    s_not_b64 s[96:97], s[94:95]
    s_waitcnt vmcnt(7)
    v_lshlrev_b32 v32, 16, v24
    v_and_b32 v33, 0xffff0000, v24
    v_lshlrev_b32 v40, 16, v28
    v_and_b32 v41, 0xffff0000, v28
    v_lshlrev_b32 v34, 16, v25
    v_and_b32 v35, 0xffff0000, v25
    v_lshlrev_b32 v42, 16, v29
    v_and_b32 v43, 0xffff0000, v29
    v_lshlrev_b32 v36, 16, v26
    v_and_b32 v37, 0xffff0000, v26
    v_lshlrev_b32 v44, 16, v30
    v_and_b32 v45, 0xffff0000, v30
    v_lshlrev_b32 v38, 16, v27
    v_and_b32 v39, 0xffff0000, v27
    v_lshlrev_b32 v46, 16, v31
    v_and_b32 v47, 0xffff0000, v31
    ds_write_b128 v15, v[32:35] offset:0
    ds_write_b128 v15, v[36:39] offset:16
    v_mul_f32 v40, -v40, v32
    v_mul_f32 v41, -v41, v33
    v_mul_f32 v42, -v42, v34
    v_mul_f32 v43, -v43, v35
    v_mul_f32 v44, -v44, v36
    v_mul_f32 v45, -v45, v37
    v_mul_f32 v46, -v46, v38
    v_mul_f32 v47, -v47, v39
    ds_write_b128 v15, v[40:43] offset:512
    ds_write_b128 v15, v[44:47] offset:528
    s_waitcnt lgkmcnt(0)
    s_barrier
    ds_read_b128 v[32:35], v7 offset:0
    ds_read_b128 v[36:39], v7 offset:512
    s_waitcnt vmcnt(6)
    v_cvt_f32_i32 v112, v112
    v_cvt_f32_i32 v113, v113
    s_mul_i32 s59, s41, 9216
    buffer_load_dwordx4 v[128:131], v1, s[20:23], s59 offen
    v_cvt_f32_i32 v114, v114
    v_cvt_f32_i32 v115, v115
    s_waitcnt vmcnt(6)
    v_cvt_f32_i32 v116, v116
    v_cvt_f32_i32 v117, v117
    v_cvt_f32_i32 v118, v118
    buffer_load_dwordx4 v[132:135], v109, s[20:23], s59 offen
    v_cvt_f32_i32 v119, v119
    s_waitcnt vmcnt(6)
    v_cvt_f32_i32 v120, v120
    buffer_load_dwordx4 v[136:139], v110, s[20:23], s59 offen
    v_cvt_f32_i32 v121, v121
    v_cvt_f32_i32 v122, v122
    v_cvt_f32_i32 v123, v123
    buffer_load_dwordx4 v[140:143], v111, s[20:23], s59 offen
    s_waitcnt vmcnt(7)
    v_cvt_f32_i32 v124, v124
    v_cvt_f32_i32 v125, v125
    s_add_u32 s61, s53, 36864
    s_cmp_ge_u32 s61, s51
    s_cselect_b32 s58, s52, 0
    s_sub_u32 s61, s61, s58
    s_add_u32 m0, s54, 81920
    s_add_u32 s57, s61, s41
    buffer_load_dwordx4 v2, s[16:19], s57 offen lds
    v_cvt_f32_i32 v126, v126
    v_cvt_f32_i32 v127, v127
    s_waitcnt lgkmcnt(0)
    v_fma_f32 v112, v112, v32, v36
    v_fma_f32 v116, v116, v32, v36
    v_fma_f32 v120, v120, v32, v36
    s_add_u32 s63, s53, 110592
    s_cmp_ge_u32 s63, s51
    s_cselect_b32 s58, s52, 0
    s_sub_u32 s63, s63, s58
    s_add_u32 m0, s54, 90112
    s_add_u32 s57, s63, s41
    buffer_load_dwordx4 v2, s[16:19], s57 offen lds
    v_fma_f32 v124, v124, v32, v36
    v_cvt_pk_bf16_f32 v40, v112, v116
    v_cvt_pk_bf16_f32 v41, v120, v124
    s_add_u32 s65, s53, 184320
    s_cmp_ge_u32 s65, s51
    s_cselect_b32 s58, s52, 0
    s_sub_u32 s65, s65, s58
    s_add_u32 m0, s54, 98304
    s_add_u32 s57, s65, s41
    buffer_load_dwordx4 v2, s[16:19], s57 offen lds
    ds_write_b64 v5, v[40:41] offset:20480
    v_fma_f32 v113, v113, v33, v37
    v_fma_f32 v117, v117, v33, v37
    v_fma_f32 v121, v121, v33, v37
    v_fma_f32 v125, v125, v33, v37
    v_cvt_pk_bf16_f32 v42, v113, v117
    v_cvt_pk_bf16_f32 v43, v121, v125
    ds_write_b64 v5, v[42:43] offset:20992
    v_fma_f32 v114, v114, v34, v38
    v_fma_f32 v118, v118, v34, v38
    v_fma_f32 v122, v122, v34, v38
    v_fma_f32 v126, v126, v34, v38
    v_cvt_pk_bf16_f32 v44, v114, v118
    v_cvt_pk_bf16_f32 v45, v122, v126
    ds_write_b64 v5, v[44:45] offset:21504
    v_fma_f32 v115, v115, v35, v39
    v_fma_f32 v119, v119, v35, v39
    v_fma_f32 v123, v123, v35, v39
    v_fma_f32 v127, v127, v35, v39
    v_cvt_pk_bf16_f32 v46, v115, v119
    v_cvt_pk_bf16_f32 v47, v123, v127
    ds_write_b64 v5, v[46:47] offset:22016
    s_waitcnt vmcnt(7) lgkmcnt(0)
    s_barrier
    ds_read_b128 v[112:115], v4 offset:20480
    ds_read_b128 v[120:123], v4 offset:28672
    ds_read_b128 v[124:127], v4 offset:29184
    ds_read_b128 v[116:119], v4 offset:20992
    ds_read_b128 v[16:19], v8 offset:53248
    ds_read_b128 v[20:23], v9 offset:53248
    ds_read_b128 v[24:27], v8 offset:57344
    ds_read_b128 v[28:31], v9 offset:57344
    ds_read_b128 v[32:35], v7 offset:2048
    ds_read_b128 v[36:39], v7 offset:2560
    s_waitcnt lgkmcnt(5)
    v_mfma_f32_16x16x32_bf16 v[60:63], v[16:19], v[112:115], 0
    s_mul_i32 s59, s42, 9216
    buffer_load_dwordx4 v[144:147], v1, s[20:23], s59 offen
    s_waitcnt vmcnt(7)
    v_cvt_f32_i32 v128, v128
    v_cvt_f32_i32 v129, v129
    s_waitcnt lgkmcnt(4)
    v_mfma_f32_16x16x32_bf16 v[60:63], v[20:23], v[120:123], v[60:63]
    buffer_load_dwordx4 v[148:151], v109, s[20:23], s59 offen
    v_cvt_f32_i32 v130, v130
    v_cvt_f32_i32 v131, v131
    s_waitcnt vmcnt(7)
    v_mfma_f32_16x16x32_bf16 v[64:67], v[20:23], v[124:127], 0
    ds_read_b128 v[20:23], v8 offset:61440
    v_cvt_f32_i32 v132, v132
    v_cvt_f32_i32 v133, v133
    v_mfma_f32_16x16x32_bf16 v[64:67], v[16:19], v[116:119], v[64:67]
    ds_read_b128 v[16:19], v9 offset:61440
    buffer_load_dwordx4 v[152:155], v110, s[20:23], s59 offen
    v_cvt_f32_i32 v134, v134
    v_cvt_f32_i32 v135, v135
    s_waitcnt vmcnt(7)
    s_waitcnt lgkmcnt(5)
    v_mfma_f32_16x16x32_bf16 v[72:75], v[24:27], v[116:119], 0
    v_cvt_f32_i32 v136, v136
    v_cvt_f32_i32 v137, v137
    s_waitcnt lgkmcnt(4)
    v_mfma_f32_16x16x32_bf16 v[72:75], v[28:31], v[124:127], v[72:75]
    buffer_load_dwordx4 v[156:159], v111, s[20:23], s59 offen
    v_cvt_f32_i32 v138, v138
    v_cvt_f32_i32 v139, v139
    s_waitcnt vmcnt(7)
    v_mfma_f32_16x16x32_bf16 v[68:71], v[28:31], v[120:123], 0
    ds_read_b128 v[28:31], v10 offset:0
    v_cvt_f32_i32 v140, v140
    v_cvt_f32_i32 v141, v141
    v_mfma_f32_16x16x32_bf16 v[68:71], v[24:27], v[112:115], v[68:71]
    ds_read_b128 v[24:27], v11 offset:0
    s_add_u32 m0, s54, 106496
    s_add_u32 s57, s61, s42
    buffer_load_dwordx4 v2, s[16:19], s57 offen lds
    v_cvt_f32_i32 v142, v142
    v_cvt_f32_i32 v143, v143
    s_waitcnt lgkmcnt(4)
    s_waitcnt lgkmcnt(3)
    v_mfma_f32_16x16x32_bf16 v[76:79], v[20:23], v[112:115], 0
    v_fma_f32 v128, v128, v32, v36
    v_fma_f32 v132, v132, v32, v36
    s_waitcnt lgkmcnt(2)
    v_mfma_f32_16x16x32_bf16 v[76:79], v[16:19], v[120:123], v[76:79]
    s_add_u32 m0, s54, 110592
    s_add_u32 s57, s62, s42
    buffer_load_dwordx4 v2, s[16:19], s57 offen lds
    v_fma_f32 v136, v136, v32, v36
    v_fma_f32 v140, v140, v32, v36
    v_mfma_f32_16x16x32_bf16 v[80:83], v[16:19], v[124:127], 0
    ds_read_b128 v[16:19], v10 offset:4096
    v_cvt_pk_bf16_f32 v40, v128, v132
    v_cvt_pk_bf16_f32 v41, v136, v140
    ds_write_b64 v5, v[40:41] offset:36864
    v_mfma_f32_16x16x32_bf16 v[80:83], v[20:23], v[116:119], v[80:83]
    ds_read_b128 v[20:23], v11 offset:4096
    s_add_u32 m0, s54, 118784
    s_add_u32 s57, s64, s42
    buffer_load_dwordx4 v2, s[16:19], s57 offen lds
    v_fma_f32 v129, v129, v33, v37
    v_fma_f32 v133, v133, v33, v37
    s_waitcnt lgkmcnt(4)
    v_mfma_f32_16x16x32_bf16 v[88:91], v[28:31], v[116:119], 0
    v_fma_f32 v137, v137, v33, v37
    v_fma_f32 v141, v141, v33, v37
    s_waitcnt lgkmcnt(3)
    v_mfma_f32_16x16x32_bf16 v[88:91], v[24:27], v[124:127], v[88:91]
    s_add_u32 m0, s54, 122880
    s_add_u32 s57, s65, s42
    buffer_load_dwordx4 v2, s[16:19], s57 offen lds
    v_cvt_pk_bf16_f32 v42, v129, v133
    v_cvt_pk_bf16_f32 v43, v137, v141
    ds_write_b64 v5, v[42:43] offset:37376
    v_mfma_f32_16x16x32_bf16 v[84:87], v[24:27], v[120:123], 0
    ds_read_b128 v[24:27], v10 offset:8192
    v_fma_f32 v130, v130, v34, v38
    v_fma_f32 v134, v134, v34, v38
    v_mfma_f32_16x16x32_bf16 v[84:87], v[28:31], v[112:115], v[84:87]
    ds_read_b128 v[28:31], v11 offset:8192
    v_fma_f32 v138, v138, v34, v38
    v_fma_f32 v142, v142, v34, v38
    s_waitcnt lgkmcnt(5)
    v_mfma_f32_16x16x32_bf16 v[92:95], v[16:19], v[112:115], 0
    v_cvt_pk_bf16_f32 v44, v130, v134
    v_cvt_pk_bf16_f32 v45, v138, v142
    ds_write_b64 v5, v[44:45] offset:37888
    s_waitcnt lgkmcnt(4)
    v_mfma_f32_16x16x32_bf16 v[92:95], v[20:23], v[120:123], v[92:95]
    v_fma_f32 v131, v131, v35, v39
    v_fma_f32 v135, v135, v35, v39
    v_fma_f32 v139, v139, v35, v39
    v_fma_f32 v143, v143, v35, v39
    v_cvt_pk_bf16_f32 v46, v131, v135
    v_cvt_pk_bf16_f32 v47, v139, v143
    ds_write_b64 v5, v[46:47] offset:38400
    s_waitcnt vmcnt(8) lgkmcnt(0)
    s_barrier
    v_mfma_f32_16x16x32_bf16 v[96:99], v[20:23], v[124:127], 0
    ds_read_b128 v[20:23], v10 offset:12288
    s_mul_i32 s59, s43, 9216
    buffer_load_dwordx4 v[160:163], v1, s[20:23], s59 offen
    s_waitcnt vmcnt(8)
    v_cvt_f32_i32 v144, v144
    v_cvt_f32_i32 v145, v145
    v_mfma_f32_16x16x32_bf16 v[96:99], v[16:19], v[116:119], v[96:99]
    ds_read_b128 v[16:19], v11 offset:12288
    ds_read_b128 v[128:131], v4 offset:36864
    v_cvt_f32_i32 v146, v146
    v_cvt_f32_i32 v147, v147
    s_waitcnt vmcnt(7)
    v_mfma_f32_16x16x32_bf16 v[104:107], v[24:27], v[116:119], 0
    ds_read_b128 v[136:139], v4 offset:45056
    buffer_load_dwordx4 v[164:167], v109, s[20:23], s59 offen
    v_cvt_f32_i32 v148, v148
    v_cvt_f32_i32 v149, v149
    v_mfma_f32_16x16x32_bf16 v[104:107], v[28:31], v[124:127], v[104:107]
    ds_read_b128 v[140:143], v4 offset:45568
    v_cvt_f32_i32 v150, v150
    v_cvt_f32_i32 v151, v151
    s_waitcnt vmcnt(7)
    v_mfma_f32_16x16x32_bf16 v[100:103], v[28:31], v[120:123], 0
    ds_read_b128 v[28:31], v10 offset:16384
    ds_read_b128 v[132:135], v4 offset:37376
    v_cvt_f32_i32 v152, v152
    v_cvt_f32_i32 v153, v153
    v_mfma_f32_16x16x32_bf16 v[100:103], v[24:27], v[112:115], v[100:103]
    ds_read_b128 v[24:27], v11 offset:16384
    ds_read_b128 v[32:35], v7 offset:4096
    ds_read_b128 v[36:39], v7 offset:4608
    buffer_load_dwordx4 v[168:171], v110, s[20:23], s59 offen
    v_cvt_f32_i32 v154, v154
    v_cvt_f32_i32 v155, v155
    s_waitcnt vmcnt(7)
    s_waitcnt lgkmcnt(7)
    v_mfma_f32_16x16x32_bf16 v[60:63], v[20:23], v[128:131], v[60:63]
    v_cvt_f32_i32 v156, v156
    v_cvt_f32_i32 v157, v157
    s_waitcnt lgkmcnt(6)
    v_mfma_f32_16x16x32_bf16 v[60:63], v[16:19], v[136:139], v[60:63]
    buffer_load_dwordx4 v[172:175], v111, s[20:23], s59 offen
    v_cvt_f32_i32 v158, v158
    v_cvt_f32_i32 v159, v159
    s_waitcnt lgkmcnt(0)
    v_mfma_f32_16x16x32_bf16 v[64:67], v[16:19], v[140:143], v[64:67]
    ds_read_b128 v[16:19], v10 offset:20480
    v_fma_f32 v144, v144, v32, v36
    v_fma_f32 v148, v148, v32, v36
    v_mfma_f32_16x16x32_bf16 v[64:67], v[20:23], v[132:135], v[64:67]
    ds_read_b128 v[20:23], v11 offset:20480
    v_fma_f32 v152, v152, v32, v36
    v_fma_f32 v156, v156, v32, v36
    v_mfma_f32_16x16x32_bf16 v[72:75], v[28:31], v[132:135], v[72:75]
    s_add_u32 m0, s54, 57344
    s_add_u32 s57, s61, s43
    buffer_load_dwordx4 v2, s[16:19], s57 offen lds
    v_cvt_pk_bf16_f32 v40, v144, v148
    v_cvt_pk_bf16_f32 v41, v152, v156
    ds_write_b64 v5, v[40:41] offset:20480
    v_mfma_f32_16x16x32_bf16 v[72:75], v[24:27], v[140:143], v[72:75]
    v_fma_f32 v145, v145, v33, v37
    v_fma_f32 v149, v149, v33, v37
    v_mfma_f32_16x16x32_bf16 v[68:71], v[24:27], v[136:139], v[68:71]
    ds_read_b128 v[24:27], v10 offset:24576
    v_fma_f32 v153, v153, v33, v37
    v_fma_f32 v157, v157, v33, v37
    v_mfma_f32_16x16x32_bf16 v[68:71], v[28:31], v[128:131], v[68:71]
    ds_read_b128 v[28:31], v11 offset:24576
    s_add_u32 m0, s54, 61440
    s_add_u32 s57, s62, s43
    buffer_load_dwordx4 v2, s[16:19], s57 offen lds
    v_cvt_pk_bf16_f32 v42, v145, v149
    v_cvt_pk_bf16_f32 v43, v153, v157
    ds_write_b64 v5, v[42:43] offset:20992
    s_waitcnt lgkmcnt(5)
    v_mfma_f32_16x16x32_bf16 v[76:79], v[16:19], v[128:131], v[76:79]
    v_fma_f32 v146, v146, v34, v38
    v_fma_f32 v150, v150, v34, v38
    s_waitcnt lgkmcnt(4)
    v_mfma_f32_16x16x32_bf16 v[76:79], v[20:23], v[136:139], v[76:79]
    v_fma_f32 v154, v154, v34, v38
    v_fma_f32 v158, v158, v34, v38
    v_mfma_f32_16x16x32_bf16 v[80:83], v[20:23], v[140:143], v[80:83]
    ds_read_b128 v[20:23], v10 offset:28672
    s_add_u32 m0, s54, 126976
    s_add_u32 s57, s64, s43
    buffer_load_dwordx4 v2, s[16:19], s57 offen lds
    v_cvt_pk_bf16_f32 v44, v146, v150
    v_cvt_pk_bf16_f32 v45, v154, v158
    ds_write_b64 v5, v[44:45] offset:21504
    v_mfma_f32_16x16x32_bf16 v[80:83], v[16:19], v[132:135], v[80:83]
    ds_read_b128 v[16:19], v11 offset:28672
    v_fma_f32 v147, v147, v35, v39
    v_fma_f32 v151, v151, v35, v39
    s_waitcnt lgkmcnt(5)
    v_mfma_f32_16x16x32_bf16 v[88:91], v[24:27], v[132:135], v[88:91]
    s_add_u32 m0, s54, 131072
    s_add_u32 s57, s65, s43
    buffer_load_dwordx4 v2, s[16:19], s57 offen lds
    v_fma_f32 v155, v155, v35, v39
    v_fma_f32 v159, v159, v35, v39
    s_waitcnt lgkmcnt(4)
    v_mfma_f32_16x16x32_bf16 v[88:91], v[28:31], v[140:143], v[88:91]
    v_cvt_pk_bf16_f32 v46, v147, v151
    v_cvt_pk_bf16_f32 v47, v155, v159
    ds_write_b64 v5, v[46:47] offset:22016
    v_mfma_f32_16x16x32_bf16 v[84:87], v[28:31], v[136:139], v[84:87]
    ds_read_b128 v[28:31], v10 offset:32768
    v_mfma_f32_16x16x32_bf16 v[84:87], v[24:27], v[128:131], v[84:87]
    ds_read_b128 v[24:27], v11 offset:32768
    s_waitcnt lgkmcnt(5)
    v_mfma_f32_16x16x32_bf16 v[92:95], v[20:23], v[128:131], v[92:95]
    s_waitcnt lgkmcnt(3)
    v_mfma_f32_16x16x32_bf16 v[92:95], v[16:19], v[136:139], v[92:95]
    s_waitcnt vmcnt(8) lgkmcnt(2)
    s_barrier
    v_mfma_f32_16x16x32_bf16 v[96:99], v[16:19], v[140:143], v[96:99]
    ds_read_b128 v[16:19], v10 offset:36864
    s_mul_i32 s59, s44, 9216
    buffer_load_dwordx4 v[176:179], v1, s[20:23], s59 offen
    s_waitcnt vmcnt(8)
    v_cvt_f32_i32 v160, v160
    v_cvt_f32_i32 v161, v161
    v_mfma_f32_16x16x32_bf16 v[96:99], v[20:23], v[132:135], v[96:99]
    ds_read_b128 v[20:23], v11 offset:36864
    ds_read_b128 v[144:147], v4 offset:20480
    v_cvt_f32_i32 v162, v162
    v_cvt_f32_i32 v163, v163
    s_waitcnt vmcnt(7)
    s_waitcnt lgkmcnt(4)
    v_mfma_f32_16x16x32_bf16 v[104:107], v[28:31], v[132:135], v[104:107]
    ds_read_b128 v[152:155], v4 offset:28672
    buffer_load_dwordx4 v[180:183], v109, s[20:23], s59 offen
    v_cvt_f32_i32 v164, v164
    v_cvt_f32_i32 v165, v165
    s_waitcnt lgkmcnt(4)
    v_mfma_f32_16x16x32_bf16 v[104:107], v[24:27], v[140:143], v[104:107]
    ds_read_b128 v[156:159], v4 offset:29184
    v_cvt_f32_i32 v166, v166
    v_cvt_f32_i32 v167, v167
    s_waitcnt vmcnt(7)
    v_mfma_f32_16x16x32_bf16 v[100:103], v[24:27], v[136:139], v[100:103]
    ds_read_b128 v[24:27], v10 offset:40960
    ds_read_b128 v[148:151], v4 offset:20992
    v_cvt_f32_i32 v168, v168
    v_cvt_f32_i32 v169, v169
    v_mfma_f32_16x16x32_bf16 v[100:103], v[28:31], v[128:131], v[100:103]
    ds_read_b128 v[28:31], v11 offset:40960
    ds_read_b128 v[32:35], v7 offset:6144
    ds_read_b128 v[36:39], v7 offset:6656
    buffer_load_dwordx4 v[184:187], v110, s[20:23], s59 offen
    v_cvt_f32_i32 v170, v170
    v_cvt_f32_i32 v171, v171
    s_waitcnt vmcnt(7)
    s_waitcnt lgkmcnt(7)
    v_mfma_f32_16x16x32_bf16 v[60:63], v[16:19], v[144:147], v[60:63]
    v_cvt_f32_i32 v172, v172
    v_cvt_f32_i32 v173, v173
    s_waitcnt lgkmcnt(6)
    v_mfma_f32_16x16x32_bf16 v[60:63], v[20:23], v[152:155], v[60:63]
    buffer_load_dwordx4 v[188:191], v111, s[20:23], s59 offen
    v_cvt_f32_i32 v174, v174
    v_cvt_f32_i32 v175, v175
    s_waitcnt lgkmcnt(0)
    v_mfma_f32_16x16x32_bf16 v[64:67], v[20:23], v[156:159], v[64:67]
    ds_read_b128 v[20:23], v10 offset:45056
    v_fma_f32 v160, v160, v32, v36
    v_fma_f32 v164, v164, v32, v36
    v_mfma_f32_16x16x32_bf16 v[64:67], v[16:19], v[148:151], v[64:67]
    ds_read_b128 v[16:19], v11 offset:45056
    v_fma_f32 v168, v168, v32, v36
    v_fma_f32 v172, v172, v32, v36
    v_mfma_f32_16x16x32_bf16 v[72:75], v[24:27], v[148:151], v[72:75]
    s_add_u32 m0, s54, 73728
    s_add_u32 s57, s61, s44
    buffer_load_dwordx4 v2, s[16:19], s57 offen lds
    v_cvt_pk_bf16_f32 v40, v160, v164
    v_cvt_pk_bf16_f32 v41, v168, v172
    ds_write_b64 v5, v[40:41] offset:36864
    v_mfma_f32_16x16x32_bf16 v[72:75], v[28:31], v[156:159], v[72:75]
    v_fma_f32 v161, v161, v33, v37
    v_fma_f32 v165, v165, v33, v37
    v_mfma_f32_16x16x32_bf16 v[68:71], v[28:31], v[152:155], v[68:71]
    ds_read_b128 v[28:31], v10 offset:49152
    v_fma_f32 v169, v169, v33, v37
    v_fma_f32 v173, v173, v33, v37
    v_mfma_f32_16x16x32_bf16 v[68:71], v[24:27], v[144:147], v[68:71]
    ds_read_b128 v[24:27], v11 offset:49152
    s_add_u32 m0, s54, 77824
    s_add_u32 s57, s62, s44
    buffer_load_dwordx4 v2, s[16:19], s57 offen lds
    v_cvt_pk_bf16_f32 v42, v161, v165
    v_cvt_pk_bf16_f32 v43, v169, v173
    ds_write_b64 v5, v[42:43] offset:37376
    s_waitcnt lgkmcnt(5)
    v_mfma_f32_16x16x32_bf16 v[76:79], v[20:23], v[144:147], v[76:79]
    v_fma_f32 v162, v162, v34, v38
    v_fma_f32 v166, v166, v34, v38
    s_waitcnt lgkmcnt(4)
    v_mfma_f32_16x16x32_bf16 v[76:79], v[16:19], v[152:155], v[76:79]
    v_fma_f32 v170, v170, v34, v38
    v_fma_f32 v174, v174, v34, v38
    v_mfma_f32_16x16x32_bf16 v[80:83], v[16:19], v[156:159], v[80:83]
    ds_read_b128 v[16:19], v10 offset:53248
    s_add_u32 m0, s54, 86016
    s_add_u32 s57, s64, s44
    buffer_load_dwordx4 v2, s[16:19], s57 offen lds
    v_cvt_pk_bf16_f32 v44, v162, v166
    v_cvt_pk_bf16_f32 v45, v170, v174
    ds_write_b64 v5, v[44:45] offset:37888
    v_mfma_f32_16x16x32_bf16 v[80:83], v[20:23], v[148:151], v[80:83]
    ds_read_b128 v[20:23], v11 offset:53248
    v_fma_f32 v163, v163, v35, v39
    v_fma_f32 v167, v167, v35, v39
    s_waitcnt lgkmcnt(5)
    v_mfma_f32_16x16x32_bf16 v[88:91], v[28:31], v[148:151], v[88:91]
    s_add_u32 m0, s54, 90112
    s_add_u32 s57, s65, s44
    buffer_load_dwordx4 v2, s[16:19], s57 offen lds
    v_fma_f32 v171, v171, v35, v39
    v_fma_f32 v175, v175, v35, v39
    s_waitcnt lgkmcnt(4)
    v_mfma_f32_16x16x32_bf16 v[88:91], v[24:27], v[156:159], v[88:91]
    v_cvt_pk_bf16_f32 v46, v163, v167
    v_cvt_pk_bf16_f32 v47, v171, v175
    ds_write_b64 v5, v[46:47] offset:38400
    v_mfma_f32_16x16x32_bf16 v[84:87], v[24:27], v[152:155], v[84:87]
    ds_read_b128 v[24:27], v10 offset:57344
    v_mfma_f32_16x16x32_bf16 v[84:87], v[28:31], v[144:147], v[84:87]
    ds_read_b128 v[28:31], v11 offset:57344
    s_waitcnt lgkmcnt(5)
    v_mfma_f32_16x16x32_bf16 v[92:95], v[16:19], v[144:147], v[92:95]
    s_waitcnt lgkmcnt(3)
    v_mfma_f32_16x16x32_bf16 v[92:95], v[20:23], v[152:155], v[92:95]
    s_waitcnt vmcnt(8) lgkmcnt(2)
    s_barrier
    v_mfma_f32_16x16x32_bf16 v[96:99], v[20:23], v[156:159], v[96:99]
    ds_read_b128 v[20:23], v8 offset:53248
    s_mul_i32 s59, s45, 9216
    buffer_load_dwordx4 v[192:195], v1, s[20:23], s59 offen
    s_waitcnt vmcnt(8)
    v_cvt_f32_i32 v176, v176
    v_cvt_f32_i32 v177, v177
    v_mfma_f32_16x16x32_bf16 v[96:99], v[16:19], v[148:151], v[96:99]
    ds_read_b128 v[16:19], v9 offset:53248
    ds_read_b128 v[160:163], v4 offset:36864
    v_cvt_f32_i32 v178, v178
    v_cvt_f32_i32 v179, v179
    s_waitcnt vmcnt(7)
    s_waitcnt lgkmcnt(4)
    v_mfma_f32_16x16x32_bf16 v[104:107], v[24:27], v[148:151], v[104:107]
    ds_read_b128 v[168:171], v4 offset:45056
    buffer_load_dwordx4 v[196:199], v109, s[20:23], s59 offen
    v_cvt_f32_i32 v180, v180
    v_cvt_f32_i32 v181, v181
    s_waitcnt lgkmcnt(4)
    v_mfma_f32_16x16x32_bf16 v[104:107], v[28:31], v[156:159], v[104:107]
    ds_read_b128 v[172:175], v4 offset:45568
    v_cvt_f32_i32 v182, v182
    v_cvt_f32_i32 v183, v183
    s_waitcnt vmcnt(7)
    v_mfma_f32_16x16x32_bf16 v[100:103], v[28:31], v[152:155], v[100:103]
    ds_read_b128 v[28:31], v8 offset:57344
    ds_read_b128 v[164:167], v4 offset:37376
    v_cvt_f32_i32 v184, v184
    v_cvt_f32_i32 v185, v185
    v_mfma_f32_16x16x32_bf16 v[100:103], v[24:27], v[144:147], v[100:103]
    ds_read_b128 v[24:27], v9 offset:57344
    ds_read_b128 v[32:35], v7 offset:8192
    ds_read_b128 v[36:39], v7 offset:8704
    buffer_load_dwordx4 v[200:203], v110, s[20:23], s59 offen
    v_cvt_f32_i32 v186, v186
    v_cvt_f32_i32 v187, v187
    s_waitcnt vmcnt(7)
    s_waitcnt lgkmcnt(7)
    v_mfma_f32_16x16x32_bf16 v[60:63], v[20:23], v[160:163], v[60:63]
    v_cvt_f32_i32 v188, v188
    v_cvt_f32_i32 v189, v189
    s_waitcnt lgkmcnt(6)
    v_mfma_f32_16x16x32_bf16 v[60:63], v[16:19], v[168:171], v[60:63]
    buffer_load_dwordx4 v[204:207], v111, s[20:23], s59 offen
    v_cvt_f32_i32 v190, v190
    v_cvt_f32_i32 v191, v191
    s_waitcnt lgkmcnt(0)
    v_mfma_f32_16x16x32_bf16 v[64:67], v[16:19], v[172:175], v[64:67]
    ds_read_b128 v[16:19], v8 offset:61440
    v_fma_f32 v176, v176, v32, v36
    v_fma_f32 v180, v180, v32, v36
    v_mfma_f32_16x16x32_bf16 v[64:67], v[20:23], v[164:167], v[64:67]
    ds_read_b128 v[20:23], v9 offset:61440
    v_fma_f32 v184, v184, v32, v36
    v_fma_f32 v188, v188, v32, v36
    v_mfma_f32_16x16x32_bf16 v[72:75], v[28:31], v[164:167], v[72:75]
    s_add_u32 m0, s54, 98304
    s_add_u32 s57, s61, s45
    buffer_load_dwordx4 v2, s[16:19], s57 offen lds
    v_cvt_pk_bf16_f32 v40, v176, v180
    v_cvt_pk_bf16_f32 v41, v184, v188
    ds_write_b64 v5, v[40:41] offset:20480
    v_mfma_f32_16x16x32_bf16 v[72:75], v[24:27], v[172:175], v[72:75]
    v_fma_f32 v177, v177, v33, v37
    v_fma_f32 v181, v181, v33, v37
    v_mfma_f32_16x16x32_bf16 v[68:71], v[24:27], v[168:171], v[68:71]
    ds_read_b128 v[24:27], v10 offset:0
    v_fma_f32 v185, v185, v33, v37
    v_fma_f32 v189, v189, v33, v37
    v_mfma_f32_16x16x32_bf16 v[68:71], v[28:31], v[160:163], v[68:71]
    ds_read_b128 v[28:31], v11 offset:0
    s_add_u32 m0, s54, 102400
    s_add_u32 s57, s62, s45
    buffer_load_dwordx4 v2, s[16:19], s57 offen lds
    v_cvt_pk_bf16_f32 v42, v177, v181
    v_cvt_pk_bf16_f32 v43, v185, v189
    ds_write_b64 v5, v[42:43] offset:20992
    s_waitcnt lgkmcnt(5)
    v_mfma_f32_16x16x32_bf16 v[76:79], v[16:19], v[160:163], v[76:79]
    v_fma_f32 v178, v178, v34, v38
    v_fma_f32 v182, v182, v34, v38
    s_waitcnt lgkmcnt(4)
    v_mfma_f32_16x16x32_bf16 v[76:79], v[20:23], v[168:171], v[76:79]
    v_fma_f32 v186, v186, v34, v38
    v_fma_f32 v190, v190, v34, v38
    v_mfma_f32_16x16x32_bf16 v[80:83], v[20:23], v[172:175], v[80:83]
    ds_read_b128 v[20:23], v10 offset:61440
    s_add_u32 m0, s54, 110592
    s_add_u32 s57, s64, s45
    buffer_load_dwordx4 v2, s[16:19], s57 offen lds
    v_cvt_pk_bf16_f32 v44, v178, v182
    v_cvt_pk_bf16_f32 v45, v186, v190
    ds_write_b64 v5, v[44:45] offset:21504
    v_mfma_f32_16x16x32_bf16 v[80:83], v[16:19], v[164:167], v[80:83]
    ds_read_b128 v[16:19], v11 offset:61440
    v_fma_f32 v179, v179, v35, v39
    v_fma_f32 v183, v183, v35, v39
    s_waitcnt lgkmcnt(5)
    v_mfma_f32_16x16x32_bf16 v[88:91], v[24:27], v[164:167], v[88:91]
    s_add_u32 m0, s54, 114688
    s_add_u32 s57, s65, s45
    buffer_load_dwordx4 v2, s[16:19], s57 offen lds
    v_fma_f32 v187, v187, v35, v39
    v_fma_f32 v191, v191, v35, v39
    s_waitcnt lgkmcnt(4)
    v_mfma_f32_16x16x32_bf16 v[88:91], v[28:31], v[172:175], v[88:91]
    v_cvt_pk_bf16_f32 v46, v179, v183
    v_cvt_pk_bf16_f32 v47, v187, v191
    ds_write_b64 v5, v[46:47] offset:22016
    v_mfma_f32_16x16x32_bf16 v[84:87], v[28:31], v[168:171], v[84:87]
    ds_read_b128 v[28:31], v12 offset:0
    v_mfma_f32_16x16x32_bf16 v[84:87], v[24:27], v[160:163], v[84:87]
    ds_read_b128 v[24:27], v13 offset:0
    s_waitcnt lgkmcnt(5)
    v_mfma_f32_16x16x32_bf16 v[92:95], v[20:23], v[160:163], v[92:95]
    s_waitcnt lgkmcnt(3)
    v_mfma_f32_16x16x32_bf16 v[92:95], v[16:19], v[168:171], v[92:95]
    s_waitcnt vmcnt(8) lgkmcnt(2)
    s_barrier
    v_mfma_f32_16x16x32_bf16 v[96:99], v[16:19], v[172:175], v[96:99]
    ds_read_b128 v[16:19], v10 offset:4096
    s_mul_i32 s59, s46, 9216
    buffer_load_dwordx4 v[208:211], v1, s[20:23], s59 offen
    s_waitcnt vmcnt(8)
    v_cvt_f32_i32 v192, v192
    v_cvt_f32_i32 v193, v193
    v_mfma_f32_16x16x32_bf16 v[96:99], v[20:23], v[164:167], v[96:99]
    ds_read_b128 v[20:23], v11 offset:4096
    ds_read_b128 v[176:179], v4 offset:20480
    v_cvt_f32_i32 v194, v194
    v_cvt_f32_i32 v195, v195
    s_waitcnt vmcnt(7)
    s_waitcnt lgkmcnt(4)
    v_mfma_f32_16x16x32_bf16 v[104:107], v[28:31], v[164:167], v[104:107]
    ds_read_b128 v[184:187], v4 offset:28672
    buffer_load_dwordx4 v[212:215], v109, s[20:23], s59 offen
    v_cvt_f32_i32 v196, v196
    v_cvt_f32_i32 v197, v197
    s_waitcnt lgkmcnt(4)
    v_mfma_f32_16x16x32_bf16 v[104:107], v[24:27], v[172:175], v[104:107]
    ds_read_b128 v[188:191], v4 offset:29184
    v_cvt_f32_i32 v198, v198
    v_cvt_f32_i32 v199, v199
    s_waitcnt vmcnt(7)
    v_mfma_f32_16x16x32_bf16 v[100:103], v[24:27], v[168:171], v[100:103]
    ds_read_b128 v[24:27], v10 offset:8192
    ds_read_b128 v[180:183], v4 offset:20992
    v_cvt_f32_i32 v200, v200
    v_cvt_f32_i32 v201, v201
    v_mfma_f32_16x16x32_bf16 v[100:103], v[28:31], v[160:163], v[100:103]
    ds_read_b128 v[28:31], v11 offset:8192
    ds_read_b128 v[32:35], v7 offset:10240
    ds_read_b128 v[36:39], v7 offset:10752
    buffer_load_dwordx4 v[216:219], v110, s[20:23], s59 offen
    v_cvt_f32_i32 v202, v202
    v_cvt_f32_i32 v203, v203
    s_waitcnt vmcnt(7)
    s_waitcnt lgkmcnt(7)
    v_mfma_f32_16x16x32_bf16 v[60:63], v[16:19], v[176:179], v[60:63]
    v_cvt_f32_i32 v204, v204
    v_cvt_f32_i32 v205, v205
    s_waitcnt lgkmcnt(6)
    v_mfma_f32_16x16x32_bf16 v[60:63], v[20:23], v[184:187], v[60:63]
    buffer_load_dwordx4 v[220:223], v111, s[20:23], s59 offen
    v_cvt_f32_i32 v206, v206
    v_cvt_f32_i32 v207, v207
    s_waitcnt lgkmcnt(0)
    v_mfma_f32_16x16x32_bf16 v[64:67], v[20:23], v[188:191], v[64:67]
    ds_read_b128 v[20:23], v10 offset:12288
    v_fma_f32 v192, v192, v32, v36
    v_fma_f32 v196, v196, v32, v36
    v_mfma_f32_16x16x32_bf16 v[64:67], v[16:19], v[180:183], v[64:67]
    ds_read_b128 v[16:19], v11 offset:12288
    v_fma_f32 v200, v200, v32, v36
    v_fma_f32 v204, v204, v32, v36
    v_mfma_f32_16x16x32_bf16 v[72:75], v[24:27], v[180:183], v[72:75]
    s_add_u32 m0, s54, 57344
    s_add_u32 s57, s61, s46
    buffer_load_dwordx4 v2, s[16:19], s57 offen lds
    v_cvt_pk_bf16_f32 v40, v192, v196
    v_cvt_pk_bf16_f32 v41, v200, v204
    ds_write_b64 v5, v[40:41] offset:36864
    v_mfma_f32_16x16x32_bf16 v[72:75], v[28:31], v[188:191], v[72:75]
    v_fma_f32 v193, v193, v33, v37
    v_fma_f32 v197, v197, v33, v37
    v_mfma_f32_16x16x32_bf16 v[68:71], v[28:31], v[184:187], v[68:71]
    ds_read_b128 v[28:31], v10 offset:16384
    v_fma_f32 v201, v201, v33, v37
    v_fma_f32 v205, v205, v33, v37
    v_mfma_f32_16x16x32_bf16 v[68:71], v[24:27], v[176:179], v[68:71]
    ds_read_b128 v[24:27], v11 offset:16384
    s_add_u32 m0, s54, 61440
    s_add_u32 s57, s62, s46
    buffer_load_dwordx4 v2, s[16:19], s57 offen lds
    v_cvt_pk_bf16_f32 v42, v193, v197
    v_cvt_pk_bf16_f32 v43, v201, v205
    ds_write_b64 v5, v[42:43] offset:37376
    s_waitcnt lgkmcnt(5)
    v_mfma_f32_16x16x32_bf16 v[76:79], v[20:23], v[176:179], v[76:79]
    v_fma_f32 v194, v194, v34, v38
    v_fma_f32 v198, v198, v34, v38
    s_waitcnt lgkmcnt(4)
    v_mfma_f32_16x16x32_bf16 v[76:79], v[16:19], v[184:187], v[76:79]
    v_fma_f32 v202, v202, v34, v38
    v_fma_f32 v206, v206, v34, v38
    v_mfma_f32_16x16x32_bf16 v[80:83], v[16:19], v[188:191], v[80:83]
    ds_read_b128 v[16:19], v10 offset:20480
    s_add_u32 m0, s54, 118784
    s_add_u32 s57, s64, s46
    buffer_load_dwordx4 v2, s[16:19], s57 offen lds
    v_cvt_pk_bf16_f32 v44, v194, v198
    v_cvt_pk_bf16_f32 v45, v202, v206
    ds_write_b64 v5, v[44:45] offset:37888
    v_mfma_f32_16x16x32_bf16 v[80:83], v[20:23], v[180:183], v[80:83]
    ds_read_b128 v[20:23], v11 offset:20480
    v_fma_f32 v195, v195, v35, v39
    v_fma_f32 v199, v199, v35, v39
    s_waitcnt lgkmcnt(5)
    v_mfma_f32_16x16x32_bf16 v[88:91], v[28:31], v[180:183], v[88:91]
    s_add_u32 m0, s54, 122880
    s_add_u32 s57, s65, s46
    buffer_load_dwordx4 v2, s[16:19], s57 offen lds
    v_fma_f32 v203, v203, v35, v39
    v_fma_f32 v207, v207, v35, v39
    s_waitcnt lgkmcnt(4)
    v_mfma_f32_16x16x32_bf16 v[88:91], v[24:27], v[188:191], v[88:91]
    v_cvt_pk_bf16_f32 v46, v195, v199
    v_cvt_pk_bf16_f32 v47, v203, v207
    ds_write_b64 v5, v[46:47] offset:38400
    v_mfma_f32_16x16x32_bf16 v[84:87], v[24:27], v[184:187], v[84:87]
    ds_read_b128 v[24:27], v10 offset:24576
    v_mfma_f32_16x16x32_bf16 v[84:87], v[28:31], v[176:179], v[84:87]
    ds_read_b128 v[28:31], v11 offset:24576
    s_waitcnt lgkmcnt(5)
    v_mfma_f32_16x16x32_bf16 v[92:95], v[16:19], v[176:179], v[92:95]
    s_waitcnt lgkmcnt(3)
    v_mfma_f32_16x16x32_bf16 v[92:95], v[20:23], v[184:187], v[92:95]
    s_waitcnt vmcnt(8) lgkmcnt(2)
    s_barrier
    v_mfma_f32_16x16x32_bf16 v[96:99], v[20:23], v[188:191], v[96:99]
    ds_read_b128 v[20:23], v10 offset:28672
    s_mul_i32 s59, s47, 9216
    buffer_load_dwordx4 v[224:227], v1, s[20:23], s59 offen
    s_waitcnt vmcnt(8)
    v_cvt_f32_i32 v208, v208
    v_cvt_f32_i32 v209, v209
    v_mfma_f32_16x16x32_bf16 v[96:99], v[16:19], v[180:183], v[96:99]
    ds_read_b128 v[16:19], v11 offset:28672
    ds_read_b128 v[192:195], v4 offset:36864
    v_cvt_f32_i32 v210, v210
    v_cvt_f32_i32 v211, v211
    s_waitcnt vmcnt(7)
    s_waitcnt lgkmcnt(4)
    v_mfma_f32_16x16x32_bf16 v[104:107], v[24:27], v[180:183], v[104:107]
    ds_read_b128 v[200:203], v4 offset:45056
    buffer_load_dwordx4 v[228:231], v109, s[20:23], s59 offen
    v_cvt_f32_i32 v212, v212
    v_cvt_f32_i32 v213, v213
    s_waitcnt lgkmcnt(4)
    v_mfma_f32_16x16x32_bf16 v[104:107], v[28:31], v[188:191], v[104:107]
    ds_read_b128 v[204:207], v4 offset:45568
    v_cvt_f32_i32 v214, v214
    v_cvt_f32_i32 v215, v215
    s_waitcnt vmcnt(7)
    v_mfma_f32_16x16x32_bf16 v[100:103], v[28:31], v[184:187], v[100:103]
    ds_read_b128 v[28:31], v10 offset:32768
    ds_read_b128 v[196:199], v4 offset:37376
    v_cvt_f32_i32 v216, v216
    v_cvt_f32_i32 v217, v217
    v_mfma_f32_16x16x32_bf16 v[100:103], v[24:27], v[176:179], v[100:103]
    ds_read_b128 v[24:27], v11 offset:32768
    ds_read_b128 v[32:35], v7 offset:12288
    ds_read_b128 v[36:39], v7 offset:12800
    buffer_load_dwordx4 v[232:235], v110, s[20:23], s59 offen
    v_cvt_f32_i32 v218, v218
    v_cvt_f32_i32 v219, v219
    s_waitcnt vmcnt(7)
    s_waitcnt lgkmcnt(7)
    v_mfma_f32_16x16x32_bf16 v[60:63], v[20:23], v[192:195], v[60:63]
    v_cvt_f32_i32 v220, v220
    v_cvt_f32_i32 v221, v221
    s_waitcnt lgkmcnt(6)
    v_mfma_f32_16x16x32_bf16 v[60:63], v[16:19], v[200:203], v[60:63]
    buffer_load_dwordx4 v[236:239], v111, s[20:23], s59 offen
    v_cvt_f32_i32 v222, v222
    v_cvt_f32_i32 v223, v223
    s_waitcnt lgkmcnt(0)
    v_mfma_f32_16x16x32_bf16 v[64:67], v[16:19], v[204:207], v[64:67]
    ds_read_b128 v[16:19], v10 offset:36864
    v_fma_f32 v208, v208, v32, v36
    v_fma_f32 v212, v212, v32, v36
    v_mfma_f32_16x16x32_bf16 v[64:67], v[20:23], v[196:199], v[64:67]
    ds_read_b128 v[20:23], v11 offset:36864
    v_fma_f32 v216, v216, v32, v36
    v_fma_f32 v220, v220, v32, v36
    v_mfma_f32_16x16x32_bf16 v[72:75], v[28:31], v[196:199], v[72:75]
    s_add_u32 m0, s54, 73728
    s_add_u32 s57, s61, s47
    buffer_load_dwordx4 v2, s[16:19], s57 offen lds
    v_cvt_pk_bf16_f32 v40, v208, v212
    v_cvt_pk_bf16_f32 v41, v216, v220
    ds_write_b64 v5, v[40:41] offset:20480
    v_mfma_f32_16x16x32_bf16 v[72:75], v[24:27], v[204:207], v[72:75]
    v_fma_f32 v209, v209, v33, v37
    v_fma_f32 v213, v213, v33, v37
    v_mfma_f32_16x16x32_bf16 v[68:71], v[24:27], v[200:203], v[68:71]
    ds_read_b128 v[24:27], v10 offset:40960
    v_fma_f32 v217, v217, v33, v37
    v_fma_f32 v221, v221, v33, v37
    v_mfma_f32_16x16x32_bf16 v[68:71], v[28:31], v[192:195], v[68:71]
    ds_read_b128 v[28:31], v11 offset:40960
    s_add_u32 m0, s54, 77824
    s_add_u32 s57, s62, s47
    buffer_load_dwordx4 v2, s[16:19], s57 offen lds
    v_cvt_pk_bf16_f32 v42, v209, v213
    v_cvt_pk_bf16_f32 v43, v217, v221
    ds_write_b64 v5, v[42:43] offset:20992
    s_waitcnt lgkmcnt(5)
    v_mfma_f32_16x16x32_bf16 v[76:79], v[16:19], v[192:195], v[76:79]
    v_fma_f32 v210, v210, v34, v38
    v_fma_f32 v214, v214, v34, v38
    s_waitcnt lgkmcnt(4)
    v_mfma_f32_16x16x32_bf16 v[76:79], v[20:23], v[200:203], v[76:79]
    v_fma_f32 v218, v218, v34, v38
    v_fma_f32 v222, v222, v34, v38
    v_mfma_f32_16x16x32_bf16 v[80:83], v[20:23], v[204:207], v[80:83]
    ds_read_b128 v[20:23], v10 offset:45056
    s_add_u32 m0, s54, 126976
    s_add_u32 s57, s64, s47
    buffer_load_dwordx4 v2, s[16:19], s57 offen lds
    v_cvt_pk_bf16_f32 v44, v210, v214
    v_cvt_pk_bf16_f32 v45, v218, v222
    ds_write_b64 v5, v[44:45] offset:21504
    v_mfma_f32_16x16x32_bf16 v[80:83], v[16:19], v[196:199], v[80:83]
    ds_read_b128 v[16:19], v11 offset:45056
    v_fma_f32 v211, v211, v35, v39
    v_fma_f32 v215, v215, v35, v39
    s_waitcnt lgkmcnt(5)
    v_mfma_f32_16x16x32_bf16 v[88:91], v[24:27], v[196:199], v[88:91]
    s_add_u32 m0, s54, 131072
    s_add_u32 s57, s65, s47
    buffer_load_dwordx4 v2, s[16:19], s57 offen lds
    v_fma_f32 v219, v219, v35, v39
    v_fma_f32 v223, v223, v35, v39
    s_waitcnt lgkmcnt(4)
    v_mfma_f32_16x16x32_bf16 v[88:91], v[28:31], v[204:207], v[88:91]
    v_cvt_pk_bf16_f32 v46, v211, v215
    v_cvt_pk_bf16_f32 v47, v219, v223
    ds_write_b64 v5, v[46:47] offset:22016
    v_mfma_f32_16x16x32_bf16 v[84:87], v[28:31], v[200:203], v[84:87]
    ds_read_b128 v[28:31], v10 offset:49152
    v_mfma_f32_16x16x32_bf16 v[84:87], v[24:27], v[192:195], v[84:87]
    ds_read_b128 v[24:27], v11 offset:49152
    s_waitcnt lgkmcnt(5)
    v_mfma_f32_16x16x32_bf16 v[92:95], v[20:23], v[192:195], v[92:95]
    s_waitcnt lgkmcnt(3)
    v_mfma_f32_16x16x32_bf16 v[92:95], v[16:19], v[200:203], v[92:95]
    s_waitcnt vmcnt(8) lgkmcnt(2)
    s_barrier
    v_mfma_f32_16x16x32_bf16 v[96:99], v[16:19], v[204:207], v[96:99]
    ds_read_b128 v[16:19], v8 offset:53248
    s_mul_i32 s59, s48, 9216
    buffer_load_dwordx4 v[240:243], v1, s[20:23], s59 offen
    s_waitcnt vmcnt(8)
    v_cvt_f32_i32 v224, v224
    v_cvt_f32_i32 v225, v225
    v_mfma_f32_16x16x32_bf16 v[96:99], v[20:23], v[196:199], v[96:99]
    ds_read_b128 v[20:23], v9 offset:53248
    ds_read_b128 v[208:211], v4 offset:20480
    v_cvt_f32_i32 v226, v226
    v_cvt_f32_i32 v227, v227
    s_waitcnt vmcnt(7)
    s_waitcnt lgkmcnt(4)
    v_mfma_f32_16x16x32_bf16 v[104:107], v[28:31], v[196:199], v[104:107]
    ds_read_b128 v[216:219], v4 offset:28672
    buffer_load_dwordx4 v[244:247], v109, s[20:23], s59 offen
    v_cvt_f32_i32 v228, v228
    v_cvt_f32_i32 v229, v229
    s_waitcnt lgkmcnt(4)
    v_mfma_f32_16x16x32_bf16 v[104:107], v[24:27], v[204:207], v[104:107]
    ds_read_b128 v[220:223], v4 offset:29184
    v_cvt_f32_i32 v230, v230
    v_cvt_f32_i32 v231, v231
    s_waitcnt vmcnt(7)
    v_mfma_f32_16x16x32_bf16 v[100:103], v[24:27], v[200:203], v[100:103]
    ds_read_b128 v[24:27], v8 offset:57344
    ds_read_b128 v[212:215], v4 offset:20992
    v_cvt_f32_i32 v232, v232
    v_cvt_f32_i32 v233, v233
    v_mfma_f32_16x16x32_bf16 v[100:103], v[28:31], v[192:195], v[100:103]
    ds_read_b128 v[28:31], v9 offset:57344
    ds_read_b128 v[32:35], v7 offset:14336
    ds_read_b128 v[36:39], v7 offset:14848
    buffer_load_dwordx4 v[248:251], v110, s[20:23], s59 offen
    v_cvt_f32_i32 v234, v234
    v_cvt_f32_i32 v235, v235
    s_waitcnt vmcnt(7)
    s_waitcnt lgkmcnt(7)
    v_mfma_f32_16x16x32_bf16 v[60:63], v[16:19], v[208:211], v[60:63]
    v_cvt_f32_i32 v236, v236
    v_cvt_f32_i32 v237, v237
    s_waitcnt lgkmcnt(6)
    v_mfma_f32_16x16x32_bf16 v[60:63], v[20:23], v[216:219], v[60:63]
    buffer_load_dwordx4 v[252:255], v111, s[20:23], s59 offen
    v_cvt_f32_i32 v238, v238
    v_cvt_f32_i32 v239, v239
    s_waitcnt lgkmcnt(0)
    v_mfma_f32_16x16x32_bf16 v[64:67], v[20:23], v[220:223], v[64:67]
    ds_read_b128 v[20:23], v8 offset:61440
    v_fma_f32 v224, v224, v32, v36
    v_fma_f32 v228, v228, v32, v36
    v_mfma_f32_16x16x32_bf16 v[64:67], v[16:19], v[212:215], v[64:67]
    ds_read_b128 v[16:19], v9 offset:61440
    v_fma_f32 v232, v232, v32, v36
    v_fma_f32 v236, v236, v32, v36
    v_mfma_f32_16x16x32_bf16 v[72:75], v[24:27], v[212:215], v[72:75]
    s_add_u32 m0, s54, 90112
    s_add_u32 s57, s61, s48
    buffer_load_dwordx4 v2, s[16:19], s57 offen lds
    v_cvt_pk_bf16_f32 v40, v224, v228
    v_cvt_pk_bf16_f32 v41, v232, v236
    ds_write_b64 v5, v[40:41] offset:36864
    v_mfma_f32_16x16x32_bf16 v[72:75], v[28:31], v[220:223], v[72:75]
    v_fma_f32 v225, v225, v33, v37
    v_fma_f32 v229, v229, v33, v37
    v_mfma_f32_16x16x32_bf16 v[68:71], v[28:31], v[216:219], v[68:71]
    ds_read_b128 v[28:31], v10 offset:0
    v_fma_f32 v233, v233, v33, v37
    v_fma_f32 v237, v237, v33, v37
    v_mfma_f32_16x16x32_bf16 v[68:71], v[24:27], v[208:211], v[68:71]
    ds_read_b128 v[24:27], v11 offset:0
    s_add_u32 m0, s54, 94208
    s_add_u32 s57, s62, s48
    buffer_load_dwordx4 v2, s[16:19], s57 offen lds
    v_cvt_pk_bf16_f32 v42, v225, v229
    v_cvt_pk_bf16_f32 v43, v233, v237
    ds_write_b64 v5, v[42:43] offset:37376
    s_waitcnt lgkmcnt(5)
    v_mfma_f32_16x16x32_bf16 v[76:79], v[20:23], v[208:211], v[76:79]
    v_fma_f32 v226, v226, v34, v38
    v_fma_f32 v230, v230, v34, v38
    s_waitcnt lgkmcnt(4)
    v_mfma_f32_16x16x32_bf16 v[76:79], v[16:19], v[216:219], v[76:79]
    v_fma_f32 v234, v234, v34, v38
    v_fma_f32 v238, v238, v34, v38
    v_mfma_f32_16x16x32_bf16 v[80:83], v[16:19], v[220:223], v[80:83]
    ds_read_b128 v[16:19], v10 offset:53248
    s_add_u32 m0, s54, 102400
    s_add_u32 s57, s64, s48
    buffer_load_dwordx4 v2, s[16:19], s57 offen lds
    v_cvt_pk_bf16_f32 v44, v226, v230
    v_cvt_pk_bf16_f32 v45, v234, v238
    ds_write_b64 v5, v[44:45] offset:37888
    v_mfma_f32_16x16x32_bf16 v[80:83], v[20:23], v[212:215], v[80:83]
    ds_read_b128 v[20:23], v11 offset:53248
    v_fma_f32 v227, v227, v35, v39
    v_fma_f32 v231, v231, v35, v39
    s_waitcnt lgkmcnt(5)
    v_mfma_f32_16x16x32_bf16 v[88:91], v[28:31], v[212:215], v[88:91]
    s_add_u32 m0, s54, 106496
    s_add_u32 s57, s65, s48
    buffer_load_dwordx4 v2, s[16:19], s57 offen lds
    v_fma_f32 v235, v235, v35, v39
    v_fma_f32 v239, v239, v35, v39
    s_waitcnt lgkmcnt(4)
    v_mfma_f32_16x16x32_bf16 v[88:91], v[24:27], v[220:223], v[88:91]
    v_cvt_pk_bf16_f32 v46, v227, v231
    v_cvt_pk_bf16_f32 v47, v235, v239
    ds_write_b64 v5, v[46:47] offset:38400
    v_mfma_f32_16x16x32_bf16 v[84:87], v[24:27], v[216:219], v[84:87]
    ds_read_b128 v[24:27], v10 offset:57344
    v_mfma_f32_16x16x32_bf16 v[84:87], v[28:31], v[208:211], v[84:87]
    ds_read_b128 v[28:31], v11 offset:57344
    s_waitcnt lgkmcnt(5)
    v_mfma_f32_16x16x32_bf16 v[92:95], v[16:19], v[208:211], v[92:95]
    s_waitcnt lgkmcnt(3)
    v_mfma_f32_16x16x32_bf16 v[92:95], v[20:23], v[216:219], v[92:95]
    s_waitcnt vmcnt(8) lgkmcnt(2)
    s_barrier
    v_mfma_f32_16x16x32_bf16 v[96:99], v[20:23], v[220:223], v[96:99]
    ds_read_b128 v[20:23], v10 offset:4096
    s_waitcnt vmcnt(7)
    v_cvt_f32_i32 v240, v240
    v_cvt_f32_i32 v241, v241
    v_mfma_f32_16x16x32_bf16 v[96:99], v[16:19], v[212:215], v[96:99]
    ds_read_b128 v[16:19], v11 offset:4096
    ds_read_b128 v[224:227], v4 offset:36864
    v_cvt_f32_i32 v242, v242
    v_cvt_f32_i32 v243, v243
    s_waitcnt vmcnt(6)
    s_waitcnt lgkmcnt(4)
    v_mfma_f32_16x16x32_bf16 v[104:107], v[24:27], v[212:215], v[104:107]
    ds_read_b128 v[232:235], v4 offset:45056
    v_cvt_f32_i32 v244, v244
    v_cvt_f32_i32 v245, v245
    s_waitcnt lgkmcnt(4)
    v_mfma_f32_16x16x32_bf16 v[104:107], v[28:31], v[220:223], v[104:107]
    ds_read_b128 v[236:239], v4 offset:45568
    v_cvt_f32_i32 v246, v246
    v_cvt_f32_i32 v247, v247
    s_waitcnt vmcnt(5)
    v_mfma_f32_16x16x32_bf16 v[100:103], v[28:31], v[216:219], v[100:103]
    ds_read_b128 v[28:31], v10 offset:8192
    ds_read_b128 v[228:231], v4 offset:37376
    v_cvt_f32_i32 v248, v248
    v_cvt_f32_i32 v249, v249
    v_mfma_f32_16x16x32_bf16 v[100:103], v[24:27], v[208:211], v[100:103]
    ds_read_b128 v[24:27], v11 offset:8192
    ds_read_b128 v[32:35], v7 offset:16384
    ds_read_b128 v[36:39], v7 offset:16896
    v_cvt_f32_i32 v250, v250
    v_cvt_f32_i32 v251, v251
    s_waitcnt vmcnt(4)
    s_waitcnt lgkmcnt(7)
    v_mfma_f32_16x16x32_bf16 v[60:63], v[20:23], v[224:227], v[60:63]
    v_cvt_f32_i32 v252, v252
    v_cvt_f32_i32 v253, v253
    s_waitcnt lgkmcnt(6)
    v_mfma_f32_16x16x32_bf16 v[60:63], v[16:19], v[232:235], v[60:63]
    v_cvt_f32_i32 v254, v254
    v_cvt_f32_i32 v255, v255
    s_waitcnt lgkmcnt(0)
    v_mfma_f32_16x16x32_bf16 v[64:67], v[16:19], v[236:239], v[64:67]
    ds_read_b128 v[16:19], v10 offset:12288
    v_fma_f32 v240, v240, v32, v36
    v_fma_f32 v244, v244, v32, v36
    v_mfma_f32_16x16x32_bf16 v[64:67], v[20:23], v[228:231], v[64:67]
    ds_read_b128 v[20:23], v11 offset:12288
    v_fma_f32 v248, v248, v32, v36
    v_fma_f32 v252, v252, v32, v36
    v_mfma_f32_16x16x32_bf16 v[72:75], v[28:31], v[228:231], v[72:75]
    v_cvt_pk_bf16_f32 v40, v240, v244
    v_cvt_pk_bf16_f32 v41, v248, v252
    ds_write_b64 v5, v[40:41] offset:20480
    v_mfma_f32_16x16x32_bf16 v[72:75], v[24:27], v[236:239], v[72:75]
    v_fma_f32 v241, v241, v33, v37
    v_fma_f32 v245, v245, v33, v37
    v_mfma_f32_16x16x32_bf16 v[68:71], v[24:27], v[232:235], v[68:71]
    ds_read_b128 v[24:27], v10 offset:16384
    v_fma_f32 v249, v249, v33, v37
    v_fma_f32 v253, v253, v33, v37
    v_mfma_f32_16x16x32_bf16 v[68:71], v[28:31], v[224:227], v[68:71]
    ds_read_b128 v[28:31], v11 offset:16384
    v_cvt_pk_bf16_f32 v42, v241, v245
    v_cvt_pk_bf16_f32 v43, v249, v253
    ds_write_b64 v5, v[42:43] offset:20992
    s_waitcnt lgkmcnt(5)
    v_mfma_f32_16x16x32_bf16 v[76:79], v[16:19], v[224:227], v[76:79]
    v_fma_f32 v242, v242, v34, v38
    v_fma_f32 v246, v246, v34, v38
    s_waitcnt lgkmcnt(4)
    v_mfma_f32_16x16x32_bf16 v[76:79], v[20:23], v[232:235], v[76:79]
    v_fma_f32 v250, v250, v34, v38
    v_fma_f32 v254, v254, v34, v38
    v_mfma_f32_16x16x32_bf16 v[80:83], v[20:23], v[236:239], v[80:83]
    ds_read_b128 v[20:23], v10 offset:61440
    v_cvt_pk_bf16_f32 v44, v242, v246
    v_cvt_pk_bf16_f32 v45, v250, v254
    ds_write_b64 v5, v[44:45] offset:21504
    v_mfma_f32_16x16x32_bf16 v[80:83], v[16:19], v[228:231], v[80:83]
    ds_read_b128 v[16:19], v11 offset:61440
    v_fma_f32 v243, v243, v35, v39
    v_fma_f32 v247, v247, v35, v39
    s_waitcnt lgkmcnt(5)
    v_mfma_f32_16x16x32_bf16 v[88:91], v[24:27], v[228:231], v[88:91]
    v_fma_f32 v251, v251, v35, v39
    v_fma_f32 v255, v255, v35, v39
    s_waitcnt lgkmcnt(4)
    v_mfma_f32_16x16x32_bf16 v[88:91], v[28:31], v[236:239], v[88:91]
    s_add_u32 s66, s53, 221184
    s_cmp_ge_u32 s66, s51
    s_cselect_b32 s58, s52, 0
    s_sub_u32 s66, s66, s58
    s_add_u32 m0, s54, 57344
    s_add_u32 s57, s66, s41
    buffer_load_dwordx4 v2, s[16:19], s57 offen lds
    v_cvt_pk_bf16_f32 v46, v243, v247
    v_cvt_pk_bf16_f32 v47, v251, v255
    ds_write_b64 v5, v[46:47] offset:22016
    v_mfma_f32_16x16x32_bf16 v[84:87], v[28:31], v[232:235], v[84:87]
    ds_read_b128 v[28:31], v12 offset:0
    v_mfma_f32_16x16x32_bf16 v[84:87], v[24:27], v[224:227], v[84:87]
    ds_read_b128 v[24:27], v13 offset:0
    s_add_u32 m0, s54, 61440
    s_add_u32 s57, s66, s42
    buffer_load_dwordx4 v2, s[16:19], s57 offen lds
    s_waitcnt lgkmcnt(5)
    v_mfma_f32_16x16x32_bf16 v[92:95], v[20:23], v[224:227], v[92:95]
    s_waitcnt lgkmcnt(3)
    v_mfma_f32_16x16x32_bf16 v[92:95], v[16:19], v[232:235], v[92:95]
    s_waitcnt vmcnt(2) lgkmcnt(2)
    s_barrier
    v_mfma_f32_16x16x32_bf16 v[96:99], v[16:19], v[236:239], v[96:99]
    ds_read_b128 v[16:19], v10 offset:20480
    s_add_u32 m0, s54, 4096
    s_add_u32 s57, s66, s45
    buffer_load_dwordx4 v2, s[16:19], s57 offen lds
    v_mfma_f32_16x16x32_bf16 v[96:99], v[20:23], v[228:231], v[96:99]
    ds_read_b128 v[20:23], v11 offset:20480
    ds_read_b128 v[240:243], v4 offset:20480
    s_waitcnt lgkmcnt(4)
    v_mfma_f32_16x16x32_bf16 v[104:107], v[28:31], v[228:231], v[104:107]
    ds_read_b128 v[248:251], v4 offset:28672
    s_add_u32 m0, s54, 8192
    s_add_u32 s57, s66, s46
    buffer_load_dwordx4 v2, s[16:19], s57 offen lds
    s_waitcnt lgkmcnt(4)
    v_mfma_f32_16x16x32_bf16 v[104:107], v[24:27], v[236:239], v[104:107]
    ds_read_b128 v[252:255], v4 offset:29184
    v_mfma_f32_16x16x32_bf16 v[100:103], v[24:27], v[232:235], v[100:103]
    ds_read_b128 v[24:27], v10 offset:24576
    ds_read_b128 v[244:247], v4 offset:20992
    v_mfma_f32_16x16x32_bf16 v[100:103], v[28:31], v[224:227], v[100:103]
    ds_read_b128 v[28:31], v11 offset:24576
    s_add_u32 m0, s54, 16384
    s_add_u32 s57, s66, s48
    buffer_load_dwordx4 v2, s[16:19], s57 offen lds
    s_waitcnt lgkmcnt(5)
    v_mfma_f32_16x16x32_bf16 v[60:63], v[16:19], v[240:243], v[60:63]
    s_waitcnt lgkmcnt(4)
    v_mfma_f32_16x16x32_bf16 v[60:63], v[20:23], v[248:251], v[60:63]
    s_add_u32 s67, s53, 258048
    s_cmp_ge_u32 s67, s51
    s_cselect_b32 s58, s52, 0
    s_sub_u32 s67, s67, s58
    s_add_u32 m0, s54, 36864
    s_add_u32 s57, s67, s40
    buffer_load_dwordx4 v2, s[16:19], s57 offen lds
    s_waitcnt lgkmcnt(3)
    v_mfma_f32_16x16x32_bf16 v[64:67], v[20:23], v[252:255], v[64:67]
    ds_read_b128 v[20:23], v10 offset:28672
    s_waitcnt lgkmcnt(2)
    v_mfma_f32_16x16x32_bf16 v[64:67], v[16:19], v[244:247], v[64:67]
    ds_read_b128 v[16:19], v11 offset:28672
    v_mfma_f32_16x16x32_bf16 v[72:75], v[24:27], v[244:247], v[72:75]
    s_add_u32 m0, s54, 45056
    s_add_u32 s57, s67, s42
    buffer_load_dwordx4 v2, s[16:19], s57 offen lds
    s_waitcnt lgkmcnt(2)
    v_mfma_f32_16x16x32_bf16 v[72:75], v[28:31], v[252:255], v[72:75]
    v_mfma_f32_16x16x32_bf16 v[68:71], v[28:31], v[248:251], v[68:71]
    ds_read_b128 v[28:31], v10 offset:32768
    v_mfma_f32_16x16x32_bf16 v[68:71], v[24:27], v[240:243], v[68:71]
    ds_read_b128 v[24:27], v11 offset:32768
    s_add_u32 m0, s54, 49152
    s_add_u32 s57, s67, s43
    buffer_load_dwordx4 v2, s[16:19], s57 offen lds
    s_waitcnt lgkmcnt(3)
    v_mfma_f32_16x16x32_bf16 v[76:79], v[20:23], v[240:243], v[76:79]
    s_waitcnt lgkmcnt(2)
    v_mfma_f32_16x16x32_bf16 v[76:79], v[16:19], v[248:251], v[76:79]
    v_mfma_f32_16x16x32_bf16 v[80:83], v[16:19], v[252:255], v[80:83]
    ds_read_b128 v[16:19], v10 offset:36864
    s_add_u32 m0, s54, 73728
    s_add_u32 s57, s67, s45
    buffer_load_dwordx4 v2, s[16:19], s57 offen lds
    v_mfma_f32_16x16x32_bf16 v[80:83], v[20:23], v[244:247], v[80:83]
    ds_read_b128 v[20:23], v11 offset:36864
    v_cvt_pk_bf16_f32 v48, v60, v64
    s_waitcnt lgkmcnt(3)
    v_mfma_f32_16x16x32_bf16 v[88:91], v[28:31], v[244:247], v[88:91]
    s_add_u32 m0, s54, 77824
    s_add_u32 s57, s67, s46
    buffer_load_dwordx4 v2, s[16:19], s57 offen lds
    v_cvt_pk_bf16_f32 v49, v61, v65
    s_waitcnt lgkmcnt(2)
    v_mfma_f32_16x16x32_bf16 v[88:91], v[24:27], v[252:255], v[88:91]
    v_cvt_pk_bf16_f32 v50, v62, v66
    v_mfma_f32_16x16x32_bf16 v[84:87], v[24:27], v[248:251], v[84:87]
    ds_read_b128 v[24:27], v10 offset:40960
    v_cvt_pk_bf16_f32 v51, v63, v67
    s_mov_b64 vcc, s[90:91]
    s_add_u32 s14, s50, 0
    v_mfma_f32_16x16x32_bf16 v[84:87], v[28:31], v[240:243], v[84:87]
    ds_read_b128 v[28:31], v11 offset:40960
    v_cndmask_b32_dpp v52, v50, v48, vcc row_ror:8 row_mask:0xf bank_mask:0xf
    s_waitcnt lgkmcnt(3)
    v_mfma_f32_16x16x32_bf16 v[92:95], v[16:19], v[240:243], v[92:95]
    v_cndmask_b32_dpp v53, v51, v49, vcc row_ror:8 row_mask:0xf bank_mask:0xf
    s_mov_b64 vcc, s[92:93]
    s_cmp_ge_u32 s14, s51
    s_cselect_b32 s49, s52, 0
    s_waitcnt lgkmcnt(2)
    v_mfma_f32_16x16x32_bf16 v[92:95], v[20:23], v[248:251], v[92:95]
    v_cndmask_b32_dpp v54, v48, v50, vcc row_ror:8 row_mask:0xf bank_mask:0xf
    s_waitcnt vmcnt(5)
    s_barrier
    v_mfma_f32_16x16x32_bf16 v[96:99], v[20:23], v[252:255], v[96:99]
    ds_read_b128 v[20:23], v8 offset:53248
    s_add_u32 m0, s54, 20480
    s_add_u32 s57, s67, s47
    buffer_load_dwordx4 v2, s[16:19], s57 offen lds
    v_cndmask_b32_dpp v55, v49, v51, vcc row_ror:8 row_mask:0xf bank_mask:0xf
    s_mov_b64 vcc, s[94:95]
    s_sub_u32 s14, s14, s49
    v_mfma_f32_16x16x32_bf16 v[96:99], v[16:19], v[244:247], v[96:99]
    ds_read_b128 v[16:19], v9 offset:53248
    v_cndmask_b32_dpp v56, v53, v52, vcc row_ror:4 row_mask:0xf bank_mask:0xf
    s_waitcnt lgkmcnt(3)
    v_mfma_f32_16x16x32_bf16 v[104:107], v[24:27], v[244:247], v[104:107]
    v_cndmask_b32_dpp v58, v55, v54, vcc row_ror:4 row_mask:0xf bank_mask:0xf
    s_mov_b64 vcc, s[96:97]
    s_lshl_b32 s14, s14, 3
    s_waitcnt lgkmcnt(2)
    v_mfma_f32_16x16x32_bf16 v[104:107], v[28:31], v[252:255], v[104:107]
    v_cndmask_b32_dpp v57, v52, v53, vcc row_ror:12 row_mask:0xf bank_mask:0xf
    v_mfma_f32_16x16x32_bf16 v[100:103], v[28:31], v[248:251], v[100:103]
    ds_read_b128 v[28:31], v8 offset:57344
    v_cndmask_b32_dpp v59, v54, v55, vcc row_ror:12 row_mask:0xf bank_mask:0xf
    buffer_store_dwordx4 v[56:59], v3, s[32:35], s14 offen nt
    v_mfma_f32_16x16x32_bf16 v[100:103], v[24:27], v[240:243], v[100:103]
    ds_read_b128 v[24:27], v9 offset:57344
    v_cvt_pk_bf16_f32 v48, v68, v72
    s_waitcnt lgkmcnt(3)
    v_mfma_f32_16x16x32_bf16 v[32:35], v[20:23], v[112:115], 0
    v_cvt_pk_bf16_f32 v49, v69, v73
    s_waitcnt lgkmcnt(2)
    v_mfma_f32_16x16x32_bf16 v[32:35], v[16:19], v[120:123], v[32:35]
    s_add_u32 s68, s53, 294912
    s_cmp_ge_u32 s68, s51
    s_cselect_b32 s58, s52, 0
    s_sub_u32 s68, s68, s58
    s_add_u32 m0, s54, 28672
    s_add_u32 s57, s68, s40
    buffer_load_dwordx4 v2, s[16:19], s57 offen lds
    v_cvt_pk_bf16_f32 v50, v70, v74
    v_mfma_f32_16x16x32_bf16 v[36:39], v[16:19], v[124:127], 0
    ds_read_b128 v[16:19], v8 offset:61440
    v_cvt_pk_bf16_f32 v51, v71, v75
    s_mov_b64 vcc, s[90:91]
    s_add_u32 s14, s50, 36864
    v_mfma_f32_16x16x32_bf16 v[36:39], v[20:23], v[116:119], v[36:39]
    ds_read_b128 v[20:23], v9 offset:61440
    v_cndmask_b32_dpp v52, v50, v48, vcc row_ror:8 row_mask:0xf bank_mask:0xf
    s_waitcnt lgkmcnt(3)
    v_mfma_f32_16x16x32_bf16 v[36:39], v[28:31], v[132:135], v[36:39]
    v_cndmask_b32_dpp v53, v51, v49, vcc row_ror:8 row_mask:0xf bank_mask:0xf
    s_mov_b64 vcc, s[92:93]
    s_cmp_ge_u32 s14, s51
    s_cselect_b32 s49, s52, 0
    s_waitcnt lgkmcnt(2)
    v_mfma_f32_16x16x32_bf16 v[36:39], v[24:27], v[140:143], v[36:39]
    v_cndmask_b32_dpp v54, v48, v50, vcc row_ror:8 row_mask:0xf bank_mask:0xf
    v_mfma_f32_16x16x32_bf16 v[32:35], v[24:27], v[136:139], v[32:35]
    ds_read_b128 v[24:27], v10 offset:0
    v_cndmask_b32_dpp v55, v49, v51, vcc row_ror:8 row_mask:0xf bank_mask:0xf
    s_mov_b64 vcc, s[94:95]
    s_sub_u32 s14, s14, s49
    v_mfma_f32_16x16x32_bf16 v[32:35], v[28:31], v[128:131], v[32:35]
    ds_read_b128 v[28:31], v11 offset:0
    v_cndmask_b32_dpp v56, v53, v52, vcc row_ror:4 row_mask:0xf bank_mask:0xf
    s_waitcnt lgkmcnt(3)
    v_mfma_f32_16x16x32_bf16 v[32:35], v[16:19], v[144:147], v[32:35]
    s_add_u32 m0, s54, 81920
    s_add_u32 s57, s68, s42
    buffer_load_dwordx4 v2, s[16:19], s57 offen lds
    v_cndmask_b32_dpp v58, v55, v54, vcc row_ror:4 row_mask:0xf bank_mask:0xf
    s_mov_b64 vcc, s[96:97]
    s_lshl_b32 s14, s14, 3
    s_waitcnt lgkmcnt(2)
    v_mfma_f32_16x16x32_bf16 v[32:35], v[20:23], v[152:155], v[32:35]
    v_cndmask_b32_dpp v57, v52, v53, vcc row_ror:12 row_mask:0xf bank_mask:0xf
    v_mfma_f32_16x16x32_bf16 v[36:39], v[20:23], v[156:159], v[36:39]
    ds_read_b128 v[20:23], v8 offset:0
    v_cndmask_b32_dpp v59, v54, v55, vcc row_ror:12 row_mask:0xf bank_mask:0xf
    buffer_store_dwordx4 v[56:59], v3, s[32:35], s14 offen nt
    v_mfma_f32_16x16x32_bf16 v[36:39], v[16:19], v[148:151], v[36:39]
    ds_read_b128 v[16:19], v9 offset:0
    v_cvt_pk_bf16_f32 v48, v76, v80
    s_waitcnt lgkmcnt(3)
    v_mfma_f32_16x16x32_bf16 v[36:39], v[24:27], v[164:167], v[36:39]
    v_cvt_pk_bf16_f32 v49, v77, v81
    s_waitcnt lgkmcnt(2)
    v_mfma_f32_16x16x32_bf16 v[36:39], v[28:31], v[172:175], v[36:39]
    v_cvt_pk_bf16_f32 v50, v78, v82
    v_mfma_f32_16x16x32_bf16 v[32:35], v[28:31], v[168:171], v[32:35]
    ds_read_b128 v[28:31], v8 offset:4096
    v_cvt_pk_bf16_f32 v51, v79, v83
    s_mov_b64 vcc, s[90:91]
    s_add_u32 s14, s50, 73728
    v_mfma_f32_16x16x32_bf16 v[32:35], v[24:27], v[160:163], v[32:35]
    ds_read_b128 v[24:27], v9 offset:4096
    s_add_u32 m0, s54, 90112
    s_add_u32 s57, s68, s44
    buffer_load_dwordx4 v2, s[16:19], s57 offen lds
    v_cndmask_b32_dpp v52, v50, v48, vcc row_ror:8 row_mask:0xf bank_mask:0xf
    s_waitcnt lgkmcnt(3)
    v_mfma_f32_16x16x32_bf16 v[32:35], v[20:23], v[176:179], v[32:35]
    v_cndmask_b32_dpp v53, v51, v49, vcc row_ror:8 row_mask:0xf bank_mask:0xf
    s_mov_b64 vcc, s[92:93]
    s_cmp_ge_u32 s14, s51
    s_cselect_b32 s49, s52, 0
    s_waitcnt lgkmcnt(2)
    v_mfma_f32_16x16x32_bf16 v[32:35], v[16:19], v[184:187], v[32:35]
    v_cndmask_b32_dpp v54, v48, v50, vcc row_ror:8 row_mask:0xf bank_mask:0xf
    v_mfma_f32_16x16x32_bf16 v[36:39], v[16:19], v[188:191], v[36:39]
    ds_read_b128 v[16:19], v8 offset:8192
    v_cndmask_b32_dpp v55, v49, v51, vcc row_ror:8 row_mask:0xf bank_mask:0xf
    s_mov_b64 vcc, s[94:95]
    s_sub_u32 s14, s14, s49
    v_mfma_f32_16x16x32_bf16 v[36:39], v[20:23], v[180:183], v[36:39]
    ds_read_b128 v[20:23], v9 offset:8192
    v_cndmask_b32_dpp v56, v53, v52, vcc row_ror:4 row_mask:0xf bank_mask:0xf
    s_waitcnt lgkmcnt(3)
    v_mfma_f32_16x16x32_bf16 v[36:39], v[28:31], v[196:199], v[36:39]
    v_cndmask_b32_dpp v58, v55, v54, vcc row_ror:4 row_mask:0xf bank_mask:0xf
    s_mov_b64 vcc, s[96:97]
    s_lshl_b32 s14, s14, 3
    s_waitcnt lgkmcnt(2)
    v_mfma_f32_16x16x32_bf16 v[36:39], v[24:27], v[204:207], v[36:39]
    s_add_u32 m0, s54, 98304
    s_add_u32 s57, s68, s46
    buffer_load_dwordx4 v2, s[16:19], s57 offen lds
    v_cndmask_b32_dpp v57, v52, v53, vcc row_ror:12 row_mask:0xf bank_mask:0xf
    v_mfma_f32_16x16x32_bf16 v[32:35], v[24:27], v[200:203], v[32:35]
    ds_read_b128 v[24:27], v8 offset:12288
    v_cndmask_b32_dpp v59, v54, v55, vcc row_ror:12 row_mask:0xf bank_mask:0xf
    buffer_store_dwordx4 v[56:59], v3, s[32:35], s14 offen nt
    v_mfma_f32_16x16x32_bf16 v[32:35], v[28:31], v[192:195], v[32:35]
    ds_read_b128 v[28:31], v9 offset:12288
    v_cvt_pk_bf16_f32 v48, v84, v88
    s_waitcnt lgkmcnt(3)
    v_mfma_f32_16x16x32_bf16 v[32:35], v[16:19], v[208:211], v[32:35]
    v_cvt_pk_bf16_f32 v49, v85, v89
    s_waitcnt lgkmcnt(2)
    v_mfma_f32_16x16x32_bf16 v[32:35], v[20:23], v[216:219], v[32:35]
    v_cvt_pk_bf16_f32 v50, v86, v90
    v_mfma_f32_16x16x32_bf16 v[36:39], v[20:23], v[220:223], v[36:39]
    ds_read_b128 v[20:23], v8 offset:16384
    v_cvt_pk_bf16_f32 v51, v87, v91
    s_mov_b64 vcc, s[90:91]
    s_add_u32 s14, s50, 110592
    v_mfma_f32_16x16x32_bf16 v[36:39], v[16:19], v[212:215], v[36:39]
    ds_read_b128 v[16:19], v9 offset:16384
    v_cndmask_b32_dpp v52, v50, v48, vcc row_ror:8 row_mask:0xf bank_mask:0xf
    s_waitcnt lgkmcnt(3)
    v_mfma_f32_16x16x32_bf16 v[36:39], v[24:27], v[228:231], v[36:39]
    v_cndmask_b32_dpp v53, v51, v49, vcc row_ror:8 row_mask:0xf bank_mask:0xf
    s_mov_b64 vcc, s[92:93]
    s_cmp_ge_u32 s14, s51
    s_cselect_b32 s49, s52, 0
    s_waitcnt lgkmcnt(2)
    v_mfma_f32_16x16x32_bf16 v[36:39], v[28:31], v[236:239], v[36:39]
    v_cndmask_b32_dpp v54, v48, v50, vcc row_ror:8 row_mask:0xf bank_mask:0xf
    s_waitcnt vmcnt(7)
    s_barrier
    v_mfma_f32_16x16x32_bf16 v[32:35], v[28:31], v[232:235], v[32:35]
    ds_read_b128 v[28:31], v8 offset:36864
    v_cndmask_b32_dpp v55, v49, v51, vcc row_ror:8 row_mask:0xf bank_mask:0xf
    s_mov_b64 vcc, s[94:95]
    s_sub_u32 s14, s14, s49
    v_mfma_f32_16x16x32_bf16 v[32:35], v[24:27], v[224:227], v[32:35]
    ds_read_b128 v[24:27], v9 offset:36864
    s_add_u32 m0, s54, 4096
    s_add_u32 s57, s68, s48
    buffer_load_dwordx4 v2, s[16:19], s57 offen lds
    v_cndmask_b32_dpp v56, v53, v52, vcc row_ror:4 row_mask:0xf bank_mask:0xf
    s_waitcnt lgkmcnt(3)
    v_mfma_f32_16x16x32_bf16 v[32:35], v[20:23], v[240:243], v[32:35]
    v_cndmask_b32_dpp v58, v55, v54, vcc row_ror:4 row_mask:0xf bank_mask:0xf
    s_mov_b64 vcc, s[96:97]
    s_lshl_b32 s14, s14, 3
    s_waitcnt lgkmcnt(2)
    v_mfma_f32_16x16x32_bf16 v[32:35], v[16:19], v[248:251], v[32:35]
    v_cndmask_b32_dpp v57, v52, v53, vcc row_ror:12 row_mask:0xf bank_mask:0xf
    v_mfma_f32_16x16x32_bf16 v[36:39], v[16:19], v[252:255], v[36:39]
    ds_read_b128 v[16:19], v8 offset:40960
    v_cndmask_b32_dpp v59, v54, v55, vcc row_ror:12 row_mask:0xf bank_mask:0xf
    buffer_store_dwordx4 v[56:59], v3, s[32:35], s14 offen nt
    v_mfma_f32_16x16x32_bf16 v[36:39], v[20:23], v[244:247], v[36:39]
    ds_read_b128 v[20:23], v9 offset:40960
    v_cvt_pk_bf16_f32 v48, v92, v96
    s_waitcnt lgkmcnt(3)
    v_mfma_f32_16x16x32_bf16 v[44:47], v[28:31], v[116:119], 0
    v_cvt_pk_bf16_f32 v49, v93, v97
    s_waitcnt lgkmcnt(2)
    v_mfma_f32_16x16x32_bf16 v[44:47], v[24:27], v[124:127], v[44:47]
    v_cvt_pk_bf16_f32 v50, v94, v98
    v_mfma_f32_16x16x32_bf16 v[40:43], v[24:27], v[120:123], 0
    ds_read_b128 v[24:27], v8 offset:45056
    v_cvt_pk_bf16_f32 v51, v95, v99
    s_mov_b64 vcc, s[90:91]
    s_add_u32 s14, s50, 147456
    v_mfma_f32_16x16x32_bf16 v[40:43], v[28:31], v[112:115], v[40:43]
    ds_read_b128 v[28:31], v9 offset:45056
    s_add_u32 s69, s53, 331776
    s_cmp_ge_u32 s69, s51
    s_cselect_b32 s58, s52, 0
    s_sub_u32 s69, s69, s58
    s_add_u32 s58, s99, 18
    s_cmp_ge_u32 s58, s55
    s_cselect_b32 s69, 0x40000000, s69
    s_add_u32 m0, s54, 53248
    s_add_u32 s57, s69, s41
    buffer_load_dwordx4 v2, s[16:19], s57 offen lds
    v_cndmask_b32_dpp v52, v50, v48, vcc row_ror:8 row_mask:0xf bank_mask:0xf
    s_waitcnt lgkmcnt(3)
    v_mfma_f32_16x16x32_bf16 v[40:43], v[16:19], v[128:131], v[40:43]
    v_cndmask_b32_dpp v53, v51, v49, vcc row_ror:8 row_mask:0xf bank_mask:0xf
    s_mov_b64 vcc, s[92:93]
    s_cmp_ge_u32 s14, s51
    s_cselect_b32 s49, s52, 0
    s_waitcnt lgkmcnt(2)
    v_mfma_f32_16x16x32_bf16 v[40:43], v[20:23], v[136:139], v[40:43]
    v_cndmask_b32_dpp v54, v48, v50, vcc row_ror:8 row_mask:0xf bank_mask:0xf
    v_mfma_f32_16x16x32_bf16 v[44:47], v[20:23], v[140:143], v[44:47]
    ds_read_b128 v[20:23], v8 offset:49152
    v_cndmask_b32_dpp v55, v49, v51, vcc row_ror:8 row_mask:0xf bank_mask:0xf
    s_mov_b64 vcc, s[94:95]
    s_sub_u32 s14, s14, s49
    v_mfma_f32_16x16x32_bf16 v[44:47], v[16:19], v[132:135], v[44:47]
    ds_read_b128 v[16:19], v9 offset:49152
    v_cndmask_b32_dpp v56, v53, v52, vcc row_ror:4 row_mask:0xf bank_mask:0xf
    s_waitcnt lgkmcnt(3)
    v_mfma_f32_16x16x32_bf16 v[44:47], v[24:27], v[148:151], v[44:47]
    v_cndmask_b32_dpp v58, v55, v54, vcc row_ror:4 row_mask:0xf bank_mask:0xf
    s_mov_b64 vcc, s[96:97]
    s_lshl_b32 s14, s14, 3
    s_waitcnt lgkmcnt(2)
    v_mfma_f32_16x16x32_bf16 v[44:47], v[28:31], v[156:159], v[44:47]
    v_cndmask_b32_dpp v57, v52, v53, vcc row_ror:12 row_mask:0xf bank_mask:0xf
    v_mfma_f32_16x16x32_bf16 v[40:43], v[28:31], v[152:155], v[40:43]
    ds_read_b128 v[28:31], v10 offset:4096
    v_cndmask_b32_dpp v59, v54, v55, vcc row_ror:12 row_mask:0xf bank_mask:0xf
    buffer_store_dwordx4 v[56:59], v3, s[32:35], s14 offen nt
    v_mfma_f32_16x16x32_bf16 v[40:43], v[24:27], v[144:147], v[40:43]
    ds_read_b128 v[24:27], v11 offset:4096
    v_cvt_pk_bf16_f32 v48, v100, v104
    s_waitcnt lgkmcnt(3)
    v_mfma_f32_16x16x32_bf16 v[40:43], v[20:23], v[160:163], v[40:43]
    s_add_u32 m0, s54, 61440
    s_add_u32 s57, s69, s43
    buffer_load_dwordx4 v2, s[16:19], s57 offen lds
    v_cvt_pk_bf16_f32 v49, v101, v105
    s_waitcnt lgkmcnt(2)
    v_mfma_f32_16x16x32_bf16 v[40:43], v[16:19], v[168:171], v[40:43]
    v_cvt_pk_bf16_f32 v50, v102, v106
    v_mfma_f32_16x16x32_bf16 v[44:47], v[16:19], v[172:175], v[44:47]
    ds_read_b128 v[16:19], v10 offset:8192
    v_cvt_pk_bf16_f32 v51, v103, v107
    s_mov_b64 vcc, s[90:91]
    s_add_u32 s14, s50, 184320
    v_mfma_f32_16x16x32_bf16 v[44:47], v[20:23], v[164:167], v[44:47]
    ds_read_b128 v[20:23], v11 offset:8192
    v_cndmask_b32_dpp v52, v50, v48, vcc row_ror:8 row_mask:0xf bank_mask:0xf
    s_waitcnt lgkmcnt(3)
    v_mfma_f32_16x16x32_bf16 v[44:47], v[28:31], v[180:183], v[44:47]
    v_cndmask_b32_dpp v53, v51, v49, vcc row_ror:8 row_mask:0xf bank_mask:0xf
    s_mov_b64 vcc, s[92:93]
    s_cmp_ge_u32 s14, s51
    s_cselect_b32 s49, s52, 0
    s_waitcnt lgkmcnt(2)
    v_mfma_f32_16x16x32_bf16 v[44:47], v[24:27], v[188:191], v[44:47]
    v_cndmask_b32_dpp v54, v48, v50, vcc row_ror:8 row_mask:0xf bank_mask:0xf
    v_mfma_f32_16x16x32_bf16 v[40:43], v[24:27], v[184:187], v[40:43]
    ds_read_b128 v[24:27], v10 offset:12288
    v_cndmask_b32_dpp v55, v49, v51, vcc row_ror:8 row_mask:0xf bank_mask:0xf
    s_mov_b64 vcc, s[94:95]
    s_sub_u32 s14, s14, s49
    v_mfma_f32_16x16x32_bf16 v[40:43], v[28:31], v[176:179], v[40:43]
    ds_read_b128 v[28:31], v11 offset:12288
    v_cndmask_b32_dpp v56, v53, v52, vcc row_ror:4 row_mask:0xf bank_mask:0xf
    s_waitcnt lgkmcnt(3)
    v_mfma_f32_16x16x32_bf16 v[40:43], v[16:19], v[192:195], v[40:43]
    s_add_u32 m0, s54, 102400
    s_add_u32 s57, s69, s45
    buffer_load_dwordx4 v2, s[16:19], s57 offen lds
    v_cndmask_b32_dpp v58, v55, v54, vcc row_ror:4 row_mask:0xf bank_mask:0xf
    s_mov_b64 vcc, s[96:97]
    s_lshl_b32 s14, s14, 3
    s_waitcnt lgkmcnt(2)
    v_mfma_f32_16x16x32_bf16 v[40:43], v[20:23], v[200:203], v[40:43]
    v_cndmask_b32_dpp v57, v52, v53, vcc row_ror:12 row_mask:0xf bank_mask:0xf
    v_mfma_f32_16x16x32_bf16 v[44:47], v[20:23], v[204:207], v[44:47]
    ds_read_b128 v[20:23], v8 offset:20480
    v_cndmask_b32_dpp v59, v54, v55, vcc row_ror:12 row_mask:0xf bank_mask:0xf
    buffer_store_dwordx4 v[56:59], v3, s[32:35], s14 offen nt
    v_mfma_f32_16x16x32_bf16 v[44:47], v[16:19], v[196:199], v[44:47]
    ds_read_b128 v[16:19], v9 offset:20480
    v_cvt_pk_bf16_f32 v48, v32, v36
    s_waitcnt lgkmcnt(3)
    v_mfma_f32_16x16x32_bf16 v[44:47], v[24:27], v[212:215], v[44:47]
    v_cvt_pk_bf16_f32 v49, v33, v37
    s_waitcnt lgkmcnt(2)
    v_mfma_f32_16x16x32_bf16 v[44:47], v[28:31], v[220:223], v[44:47]
    v_cvt_pk_bf16_f32 v50, v34, v38
    v_mfma_f32_16x16x32_bf16 v[40:43], v[28:31], v[216:219], v[40:43]
    ds_read_b128 v[28:31], v8 offset:24576
    v_cvt_pk_bf16_f32 v51, v35, v39
    s_mov_b64 vcc, s[90:91]
    s_add_u32 s14, s50, 221184
    v_mfma_f32_16x16x32_bf16 v[40:43], v[24:27], v[208:211], v[40:43]
    ds_read_b128 v[24:27], v9 offset:24576
    v_cndmask_b32_dpp v52, v50, v48, vcc row_ror:8 row_mask:0xf bank_mask:0xf
    s_waitcnt lgkmcnt(3)
    v_mfma_f32_16x16x32_bf16 v[40:43], v[20:23], v[224:227], v[40:43]
    v_cndmask_b32_dpp v53, v51, v49, vcc row_ror:8 row_mask:0xf bank_mask:0xf
    s_mov_b64 vcc, s[92:93]
    s_cmp_ge_u32 s14, s51
    s_cselect_b32 s49, s52, 0
    s_waitcnt lgkmcnt(2)
    v_mfma_f32_16x16x32_bf16 v[40:43], v[16:19], v[232:235], v[40:43]
    v_cndmask_b32_dpp v54, v48, v50, vcc row_ror:8 row_mask:0xf bank_mask:0xf
    s_waitcnt vmcnt(6)
    s_barrier
    v_mfma_f32_16x16x32_bf16 v[44:47], v[16:19], v[236:239], v[44:47]
    ds_read_b128 v[16:19], v8 offset:28672
    v_cndmask_b32_dpp v55, v49, v51, vcc row_ror:8 row_mask:0xf bank_mask:0xf
    s_mov_b64 vcc, s[94:95]
    s_sub_u32 s14, s14, s49
    v_mfma_f32_16x16x32_bf16 v[44:47], v[20:23], v[228:231], v[44:47]
    ds_read_b128 v[20:23], v9 offset:28672
    v_cndmask_b32_dpp v56, v53, v52, vcc row_ror:4 row_mask:0xf bank_mask:0xf
    s_waitcnt lgkmcnt(3)
    v_mfma_f32_16x16x32_bf16 v[44:47], v[28:31], v[244:247], v[44:47]
    v_cndmask_b32_dpp v58, v55, v54, vcc row_ror:4 row_mask:0xf bank_mask:0xf
    s_mov_b64 vcc, s[96:97]
    s_lshl_b32 s14, s14, 3
    s_waitcnt lgkmcnt(2)
    v_mfma_f32_16x16x32_bf16 v[44:47], v[24:27], v[252:255], v[44:47]
    v_cndmask_b32_dpp v57, v52, v53, vcc row_ror:12 row_mask:0xf bank_mask:0xf
    v_mfma_f32_16x16x32_bf16 v[40:43], v[24:27], v[248:251], v[40:43]
    ds_read_b128 v[24:27], v8 offset:32768
    v_cndmask_b32_dpp v59, v54, v55, vcc row_ror:12 row_mask:0xf bank_mask:0xf
    buffer_store_dwordx4 v[56:59], v3, s[32:35], s14 offen nt
    v_mfma_f32_16x16x32_bf16 v[40:43], v[28:31], v[240:243], v[40:43]
    ds_read_b128 v[28:31], v9 offset:32768
    s_waitcnt lgkmcnt(3)
    v_mfma_f32_16x16x32_bf16 v[32:35], v[16:19], v[112:115], 0
    s_waitcnt lgkmcnt(2)
    v_mfma_f32_16x16x32_bf16 v[32:35], v[20:23], v[120:123], v[32:35]
    s_add_u32 m0, s54, 12288
    s_add_u32 s57, s69, s47
    buffer_load_dwordx4 v2, s[16:19], s57 offen lds
    v_mfma_f32_16x16x32_bf16 v[36:39], v[20:23], v[124:127], 0
    ds_read_b128 v[20:23], v10 offset:16384
    v_mfma_f32_16x16x32_bf16 v[36:39], v[16:19], v[116:119], v[36:39]
    ds_read_b128 v[16:19], v11 offset:16384
    s_waitcnt lgkmcnt(3)
    v_mfma_f32_16x16x32_bf16 v[36:39], v[24:27], v[132:135], v[36:39]
    s_waitcnt lgkmcnt(2)
    v_mfma_f32_16x16x32_bf16 v[36:39], v[28:31], v[140:143], v[36:39]
    v_mfma_f32_16x16x32_bf16 v[32:35], v[28:31], v[136:139], v[32:35]
    ds_read_b128 v[28:31], v10 offset:20480
    v_mfma_f32_16x16x32_bf16 v[32:35], v[24:27], v[128:131], v[32:35]
    ds_read_b128 v[24:27], v11 offset:20480
    v_cvt_pk_bf16_f32 v48, v40, v44
    s_waitcnt lgkmcnt(3)
    v_mfma_f32_16x16x32_bf16 v[32:35], v[20:23], v[144:147], v[32:35]
    v_cvt_pk_bf16_f32 v49, v41, v45
    s_waitcnt lgkmcnt(2)
    v_mfma_f32_16x16x32_bf16 v[32:35], v[16:19], v[152:155], v[32:35]
    v_cvt_pk_bf16_f32 v50, v42, v46
    v_mfma_f32_16x16x32_bf16 v[36:39], v[16:19], v[156:159], v[36:39]
    ds_read_b128 v[16:19], v10 offset:24576
    v_cvt_pk_bf16_f32 v51, v43, v47
    s_mov_b64 vcc, s[90:91]
    s_add_u32 s14, s50, 258048
    v_mfma_f32_16x16x32_bf16 v[36:39], v[20:23], v[148:151], v[36:39]
    ds_read_b128 v[20:23], v11 offset:24576
    v_cndmask_b32_dpp v52, v50, v48, vcc row_ror:8 row_mask:0xf bank_mask:0xf
    s_waitcnt lgkmcnt(3)
    v_mfma_f32_16x16x32_bf16 v[36:39], v[28:31], v[164:167], v[36:39]
    v_cndmask_b32_dpp v53, v51, v49, vcc row_ror:8 row_mask:0xf bank_mask:0xf
    s_mov_b64 vcc, s[92:93]
    s_cmp_ge_u32 s14, s51
    s_cselect_b32 s49, s52, 0
    s_waitcnt lgkmcnt(2)
    v_mfma_f32_16x16x32_bf16 v[36:39], v[24:27], v[172:175], v[36:39]
    v_cndmask_b32_dpp v54, v48, v50, vcc row_ror:8 row_mask:0xf bank_mask:0xf
    v_mfma_f32_16x16x32_bf16 v[32:35], v[24:27], v[168:171], v[32:35]
    ds_read_b128 v[24:27], v10 offset:28672
    v_cndmask_b32_dpp v55, v49, v51, vcc row_ror:8 row_mask:0xf bank_mask:0xf
    s_mov_b64 vcc, s[94:95]
    s_sub_u32 s14, s14, s49
    v_mfma_f32_16x16x32_bf16 v[32:35], v[28:31], v[160:163], v[32:35]
    ds_read_b128 v[28:31], v11 offset:28672
    v_cndmask_b32_dpp v56, v53, v52, vcc row_ror:4 row_mask:0xf bank_mask:0xf
    s_waitcnt lgkmcnt(3)
    v_mfma_f32_16x16x32_bf16 v[32:35], v[16:19], v[176:179], v[32:35]
    v_cndmask_b32_dpp v58, v55, v54, vcc row_ror:4 row_mask:0xf bank_mask:0xf
    s_mov_b64 vcc, s[96:97]
    s_lshl_b32 s14, s14, 3
    s_waitcnt lgkmcnt(2)
    v_mfma_f32_16x16x32_bf16 v[32:35], v[20:23], v[184:187], v[32:35]
    v_cndmask_b32_dpp v57, v52, v53, vcc row_ror:12 row_mask:0xf bank_mask:0xf
    v_mfma_f32_16x16x32_bf16 v[36:39], v[20:23], v[188:191], v[36:39]
    ds_read_b128 v[20:23], v10 offset:32768
    v_cndmask_b32_dpp v59, v54, v55, vcc row_ror:12 row_mask:0xf bank_mask:0xf
    buffer_store_dwordx4 v[56:59], v3, s[32:35], s14 offen nt
    v_mfma_f32_16x16x32_bf16 v[36:39], v[16:19], v[180:183], v[36:39]
    ds_read_b128 v[16:19], v11 offset:32768
    s_waitcnt lgkmcnt(3)
    v_mfma_f32_16x16x32_bf16 v[36:39], v[24:27], v[196:199], v[36:39]
    s_waitcnt lgkmcnt(2)
    v_mfma_f32_16x16x32_bf16 v[36:39], v[28:31], v[204:207], v[36:39]
    v_mfma_f32_16x16x32_bf16 v[32:35], v[28:31], v[200:203], v[32:35]
    ds_read_b128 v[28:31], v8 offset:0
    v_mfma_f32_16x16x32_bf16 v[32:35], v[24:27], v[192:195], v[32:35]
    ds_read_b128 v[24:27], v9 offset:0
    s_waitcnt lgkmcnt(3)
    v_mfma_f32_16x16x32_bf16 v[32:35], v[20:23], v[208:211], v[32:35]
    s_waitcnt lgkmcnt(2)
    v_mfma_f32_16x16x32_bf16 v[32:35], v[16:19], v[216:219], v[32:35]
    v_mfma_f32_16x16x32_bf16 v[36:39], v[16:19], v[220:223], v[36:39]
    ds_read_b128 v[16:19], v8 offset:4096
    v_mfma_f32_16x16x32_bf16 v[36:39], v[20:23], v[212:215], v[36:39]
    ds_read_b128 v[20:23], v9 offset:4096
    s_waitcnt lgkmcnt(3)
    v_mfma_f32_16x16x32_bf16 v[36:39], v[28:31], v[228:231], v[36:39]
    s_waitcnt lgkmcnt(2)
    v_mfma_f32_16x16x32_bf16 v[36:39], v[24:27], v[236:239], v[36:39]
    s_waitcnt vmcnt(1)
    s_barrier
    v_mfma_f32_16x16x32_bf16 v[32:35], v[24:27], v[232:235], v[32:35]
    ds_read_b128 v[24:27], v8 offset:8192
    v_mfma_f32_16x16x32_bf16 v[32:35], v[28:31], v[224:227], v[32:35]
    ds_read_b128 v[28:31], v9 offset:8192
    s_waitcnt lgkmcnt(3)
    v_mfma_f32_16x16x32_bf16 v[32:35], v[16:19], v[240:243], v[32:35]
    s_waitcnt lgkmcnt(2)
    v_mfma_f32_16x16x32_bf16 v[32:35], v[20:23], v[248:251], v[32:35]
    v_mfma_f32_16x16x32_bf16 v[36:39], v[20:23], v[252:255], v[36:39]
    ds_read_b128 v[20:23], v8 offset:53248
    v_mfma_f32_16x16x32_bf16 v[36:39], v[16:19], v[244:247], v[36:39]
    ds_read_b128 v[16:19], v9 offset:53248
    s_cmp_eq_u32 s55, 18
    s_cbranch_scc1 L_skip
    s_waitcnt lgkmcnt(3)
    v_mfma_f32_16x16x32_bf16 v[44:47], v[24:27], v[116:119], 0
    s_waitcnt lgkmcnt(2)
    v_mfma_f32_16x16x32_bf16 v[44:47], v[28:31], v[124:127], v[44:47]
    v_mfma_f32_16x16x32_bf16 v[40:43], v[28:31], v[120:123], 0
    ds_read_b128 v[28:31], v8 offset:57344
    v_mfma_f32_16x16x32_bf16 v[40:43], v[24:27], v[112:115], v[40:43]
    ds_read_b128 v[24:27], v9 offset:57344
    s_waitcnt lgkmcnt(3)
    v_mfma_f32_16x16x32_bf16 v[40:43], v[20:23], v[128:131], v[40:43]
    s_waitcnt lgkmcnt(2)
    v_mfma_f32_16x16x32_bf16 v[40:43], v[16:19], v[136:139], v[40:43]
    v_mfma_f32_16x16x32_bf16 v[44:47], v[16:19], v[140:143], v[44:47]
    ds_read_b128 v[16:19], v8 offset:61440
    v_mfma_f32_16x16x32_bf16 v[44:47], v[20:23], v[132:135], v[44:47]
    ds_read_b128 v[20:23], v9 offset:61440
    v_cvt_pk_bf16_f32 v48, v32, v36
    s_waitcnt lgkmcnt(3)
    v_mfma_f32_16x16x32_bf16 v[44:47], v[28:31], v[148:151], v[44:47]
    v_cvt_pk_bf16_f32 v49, v33, v37
    s_waitcnt lgkmcnt(2)
    v_mfma_f32_16x16x32_bf16 v[44:47], v[24:27], v[156:159], v[44:47]
    v_cvt_pk_bf16_f32 v50, v34, v38
    v_mfma_f32_16x16x32_bf16 v[40:43], v[24:27], v[152:155], v[40:43]
    ds_read_b128 v[24:27], v10 offset:0
    v_cvt_pk_bf16_f32 v51, v35, v39
    s_mov_b64 vcc, s[90:91]
    s_add_u32 s14, s50, 294912
    v_mfma_f32_16x16x32_bf16 v[40:43], v[28:31], v[144:147], v[40:43]
    ds_read_b128 v[28:31], v11 offset:0
    v_cndmask_b32_dpp v52, v50, v48, vcc row_ror:8 row_mask:0xf bank_mask:0xf
    s_waitcnt lgkmcnt(3)
    v_mfma_f32_16x16x32_bf16 v[40:43], v[16:19], v[160:163], v[40:43]
    v_cndmask_b32_dpp v53, v51, v49, vcc row_ror:8 row_mask:0xf bank_mask:0xf
    s_mov_b64 vcc, s[92:93]
    s_cmp_ge_u32 s14, s51
    s_cselect_b32 s49, s52, 0
    s_waitcnt lgkmcnt(2)
    v_mfma_f32_16x16x32_bf16 v[40:43], v[20:23], v[168:171], v[40:43]
    v_cndmask_b32_dpp v54, v48, v50, vcc row_ror:8 row_mask:0xf bank_mask:0xf
    v_mfma_f32_16x16x32_bf16 v[44:47], v[20:23], v[172:175], v[44:47]
    ds_read_b128 v[20:23], v10 offset:36864
    v_cndmask_b32_dpp v55, v49, v51, vcc row_ror:8 row_mask:0xf bank_mask:0xf
    s_mov_b64 vcc, s[94:95]
    s_sub_u32 s14, s14, s49
    v_mfma_f32_16x16x32_bf16 v[44:47], v[16:19], v[164:167], v[44:47]
    ds_read_b128 v[16:19], v11 offset:36864
    v_cndmask_b32_dpp v56, v53, v52, vcc row_ror:4 row_mask:0xf bank_mask:0xf
    s_waitcnt lgkmcnt(3)
    v_mfma_f32_16x16x32_bf16 v[44:47], v[24:27], v[180:183], v[44:47]
    v_cndmask_b32_dpp v58, v55, v54, vcc row_ror:4 row_mask:0xf bank_mask:0xf
    s_mov_b64 vcc, s[96:97]
    s_lshl_b32 s14, s14, 3
    s_waitcnt lgkmcnt(2)
    v_mfma_f32_16x16x32_bf16 v[44:47], v[28:31], v[188:191], v[44:47]
    v_cndmask_b32_dpp v57, v52, v53, vcc row_ror:12 row_mask:0xf bank_mask:0xf
    v_mfma_f32_16x16x32_bf16 v[40:43], v[28:31], v[184:187], v[40:43]
    ds_read_b128 v[28:31], v10 offset:40960
    v_cndmask_b32_dpp v59, v54, v55, vcc row_ror:12 row_mask:0xf bank_mask:0xf
    buffer_store_dwordx4 v[56:59], v3, s[32:35], s14 offen nt
    v_mfma_f32_16x16x32_bf16 v[40:43], v[24:27], v[176:179], v[40:43]
    ds_read_b128 v[24:27], v11 offset:40960
    s_waitcnt lgkmcnt(3)
    v_mfma_f32_16x16x32_bf16 v[40:43], v[20:23], v[192:195], v[40:43]
    s_waitcnt lgkmcnt(2)
    v_mfma_f32_16x16x32_bf16 v[40:43], v[16:19], v[200:203], v[40:43]
    v_mfma_f32_16x16x32_bf16 v[44:47], v[16:19], v[204:207], v[44:47]
    ds_read_b128 v[16:19], v8 offset:12288
    v_mfma_f32_16x16x32_bf16 v[44:47], v[20:23], v[196:199], v[44:47]
    ds_read_b128 v[20:23], v9 offset:12288
    s_waitcnt lgkmcnt(3)
    v_mfma_f32_16x16x32_bf16 v[44:47], v[28:31], v[212:215], v[44:47]
    s_waitcnt lgkmcnt(2)
    v_mfma_f32_16x16x32_bf16 v[44:47], v[24:27], v[220:223], v[44:47]
    v_mfma_f32_16x16x32_bf16 v[40:43], v[24:27], v[216:219], v[40:43]
    ds_read_b128 v[24:27], v8 offset:16384
    v_mfma_f32_16x16x32_bf16 v[40:43], v[28:31], v[208:211], v[40:43]
    ds_read_b128 v[28:31], v9 offset:16384
    s_waitcnt lgkmcnt(3)
    v_mfma_f32_16x16x32_bf16 v[40:43], v[16:19], v[224:227], v[40:43]
    s_waitcnt lgkmcnt(2)
    v_mfma_f32_16x16x32_bf16 v[40:43], v[20:23], v[232:235], v[40:43]
    v_mfma_f32_16x16x32_bf16 v[44:47], v[20:23], v[236:239], v[44:47]
    v_mfma_f32_16x16x32_bf16 v[44:47], v[16:19], v[228:231], v[44:47]
    s_waitcnt lgkmcnt(1)
    v_mfma_f32_16x16x32_bf16 v[44:47], v[24:27], v[244:247], v[44:47]
    s_waitcnt lgkmcnt(0)
    v_mfma_f32_16x16x32_bf16 v[44:47], v[28:31], v[252:255], v[44:47]
    v_mfma_f32_16x16x32_bf16 v[40:43], v[28:31], v[248:251], v[40:43]
    v_mfma_f32_16x16x32_bf16 v[40:43], v[24:27], v[240:243], v[40:43]
    s_nop 7
    s_nop 4
    v_cvt_pk_bf16_f32 v48, v40, v44
    v_cvt_pk_bf16_f32 v49, v41, v45
    v_cvt_pk_bf16_f32 v50, v42, v46
    v_cvt_pk_bf16_f32 v51, v43, v47
    s_mov_b64 vcc, s[90:91]
    s_add_u32 s14, s50, 331776
    v_cndmask_b32_dpp v52, v50, v48, vcc row_ror:8 row_mask:0xf bank_mask:0xf
    v_cndmask_b32_dpp v53, v51, v49, vcc row_ror:8 row_mask:0xf bank_mask:0xf
    s_mov_b64 vcc, s[92:93]
    s_cmp_ge_u32 s14, s51
    s_cselect_b32 s49, s52, 0
    v_cndmask_b32_dpp v54, v48, v50, vcc row_ror:8 row_mask:0xf bank_mask:0xf
    v_cndmask_b32_dpp v55, v49, v51, vcc row_ror:8 row_mask:0xf bank_mask:0xf
    s_mov_b64 vcc, s[94:95]
    s_sub_u32 s14, s14, s49
    v_cndmask_b32_dpp v56, v53, v52, vcc row_ror:4 row_mask:0xf bank_mask:0xf
    v_cndmask_b32_dpp v58, v55, v54, vcc row_ror:4 row_mask:0xf bank_mask:0xf
    s_mov_b64 vcc, s[96:97]
    s_lshl_b32 s14, s14, 3
    v_cndmask_b32_dpp v57, v52, v53, vcc row_ror:12 row_mask:0xf bank_mask:0xf
    v_cndmask_b32_dpp v59, v54, v55, vcc row_ror:12 row_mask:0xf bank_mask:0xf
    buffer_store_dwordx4 v[56:59], v3, s[32:35], s14 offen nt
    s_branch L_end
L_skip:
    s_nop 1
    s_nop 3
    v_cvt_pk_bf16_f32 v48, v32, v36
    v_cvt_pk_bf16_f32 v49, v33, v37
    v_cvt_pk_bf16_f32 v50, v34, v38
    v_cvt_pk_bf16_f32 v51, v35, v39
    s_mov_b64 vcc, s[90:91]
    s_add_u32 s14, s50, 294912
    v_cndmask_b32_dpp v52, v50, v48, vcc row_ror:8 row_mask:0xf bank_mask:0xf
    v_cndmask_b32_dpp v53, v51, v49, vcc row_ror:8 row_mask:0xf bank_mask:0xf
    s_mov_b64 vcc, s[92:93]
    s_cmp_ge_u32 s14, s51
    s_cselect_b32 s49, s52, 0
    v_cndmask_b32_dpp v54, v48, v50, vcc row_ror:8 row_mask:0xf bank_mask:0xf
    v_cndmask_b32_dpp v55, v49, v51, vcc row_ror:8 row_mask:0xf bank_mask:0xf
    s_mov_b64 vcc, s[94:95]
    s_sub_u32 s14, s14, s49
    v_cndmask_b32_dpp v56, v53, v52, vcc row_ror:4 row_mask:0xf bank_mask:0xf
    v_cndmask_b32_dpp v58, v55, v54, vcc row_ror:4 row_mask:0xf bank_mask:0xf
    s_mov_b64 vcc, s[96:97]
    s_lshl_b32 s14, s14, 3
    v_cndmask_b32_dpp v57, v52, v53, vcc row_ror:12 row_mask:0xf bank_mask:0xf
    v_cndmask_b32_dpp v59, v54, v55, vcc row_ror:12 row_mask:0xf bank_mask:0xf
    buffer_store_dwordx4 v[56:59], v3, s[32:35], s14 offen nt
L_end:
    s_endpgm
L_rh1:
    s_cmp_eq_u32 s56, 4
    s_cselect_b32 exec_lo, -1, 0
    s_mov_b32 exec_hi, 0
    s_waitcnt lgkmcnt(0)
    buffer_load_dwordx4 v[48:51], v14, s[24:27], 0 offen
    buffer_load_dwordx4 v[52:55], v14, s[28:31], 0 offen
    s_mov_b64 exec, -1
    s_mul_i32 s59, s40, 9216
    buffer_load_dwordx4 v[112:115], v1, s[20:23], s59 offen
    buffer_load_dwordx4 v[116:119], v109, s[20:23], s59 offen
    buffer_load_dwordx4 v[120:123], v110, s[20:23], s59 offen
    buffer_load_dwordx4 v[124:127], v111, s[20:23], s59 offen
    s_cmp_lt_u32 s15, 2
    s_cselect_b32 s55, 19, 18
    v_and_b32 v21, 15, v0
    s_min_u32 s100, s15, 2
    s_mul_i32 s57, s15, 18
    s_add_u32 s100, s100, s57
    v_bfe_u32 v22, v0, 4, 2
    s_add_u32 s57, s100, s55
    s_mul_i32 s51, s57, 18432
    s_mul_i32 s52, s55, 18432
    s_and_b32 s98, s56, 1
    s_bfe_u32 s99, s56, 0x10001
    s_lshl_b32 s57, s98, 2
    v_add_u32 v16, s57, v22
    v_and_b32 v17, 7, v20
    v_xor_b32 v16, v16, v17
    s_sub_u32 s57, s13, 5
    s_cmp_ge_u32 s13, 5
    s_cselect_b32 s57, s57, s13
    s_mul_i32 s57, s57, 4
    s_add_u32 s100, s100, s57
    v_lshrrev_b32 v17, 3, v20
    v_mul_u32_u24 v17, 1152, v17
    v_lshl_add_u32 v2, v16, 4, v17
    s_mul_i32 s50, s100, 18432
    s_mul_i32 s57, s98, 9216
    v_add_u32 v2, s57, v2
    s_mul_i32 s57, s99, 18432
    s_add_u32 s53, s50, s57
    s_lshl_b32 s54, s56, 10
    s_and_b32 s54, s54, 0xc00
    s_mov_b32 s18, 2359296
    s_mov_b32 s19, 0x00020000
    s_add_u32 s61, s53, 36864
    s_cmp_ge_u32 s61, s51
    s_cselect_b32 s58, s52, 0
    s_sub_u32 s61, s61, s58
    s_add_u32 m0, s54, 57344
    s_add_u32 s57, s61, s40
    buffer_load_dwordx4 v2, s[16:19], s57 offen lds
    s_add_u32 s63, s53, 110592
    s_cmp_ge_u32 s63, s51
    s_cselect_b32 s58, s52, 0
    s_sub_u32 s63, s63, s58
    s_add_u32 m0, s54, 65536
    s_add_u32 s57, s63, s40
    buffer_load_dwordx4 v2, s[16:19], s57 offen lds
    s_add_u32 s65, s53, 184320
    s_cmp_ge_u32 s65, s51
    s_cselect_b32 s58, s52, 0
    s_sub_u32 s65, s65, s58
    s_add_u32 m0, s54, 73728
    s_add_u32 s57, s65, s40
    buffer_load_dwordx4 v2, s[16:19], s57 offen lds
    s_add_u32 s41, s40, 128
    s_cmp_eq_u32 s41, 1152
    s_cselect_b32 s41, 0, s41
    s_add_u32 s42, s41, 128
    s_cmp_eq_u32 s42, 1152
    s_cselect_b32 s42, 0, s42
    s_add_u32 s43, s42, 128
    s_cmp_eq_u32 s43, 1152
    s_cselect_b32 s43, 0, s43
    s_add_u32 s44, s43, 128
    s_cmp_eq_u32 s44, 1152
    s_cselect_b32 s44, 0, s44
    s_add_u32 s45, s44, 128
    s_cmp_eq_u32 s45, 1152
    s_cselect_b32 s45, 0, s45
    s_add_u32 s46, s45, 128
    s_cmp_eq_u32 s46, 1152
    s_cselect_b32 s46, 0, s46
    s_add_u32 s47, s46, 128
    s_cmp_eq_u32 s47, 1152
    s_cselect_b32 s47, 0, s47
    s_add_u32 s48, s47, 128
    s_cmp_eq_u32 s48, 1152
    s_cselect_b32 s48, 0, s48
    s_mov_b32 s34, 18874368
    s_mov_b32 s35, 0x00020000
    v_lshrrev_b32 v16, 2, v20
    v_mul_u32_u24 v16, 9216, v16
    v_and_b32 v17, 3, v20
    v_lshl_add_u32 v16, v17, 4, v16
    s_lshr_b32 s57, s54, 4
    s_lshl_b32 s58, s3, 8
    s_add_u32 s57, s57, s58
    v_add_u32 v3, s57, v16
    v_bfe_u32 v16, v21, 2, 1
    v_and_b32 v17, 3, v21
    v_lshlrev_b32 v17, 1, v17
    v_lshrrev_b32 v18, 3, v21
    v_add_u32 v17, v17, v18
    v_lshlrev_b32 v17, 4, v17
    v_lshl_add_u32 v17, v16, 10, v17
    v_lshl_add_u32 v17, v22, 7, v17
    s_lshl_b32 s57, s54, 1
    v_add_u32 v4, s57, v17
    v_and_b32 v16, 7, v21
    v_lshlrev_b32 v16, 4, v16
    v_lshl_add_u32 v17, v18, 3, v16
    v_lshl_add_u32 v17, v22, 7, v17
    s_add_u32 s57, s57, 8192
    v_add_u32 v5, s57, v17
    s_lshr_b32 s57, s54, 3
    s_add_u32 s57, s57, 1024
    v_add_u32 v7, s57, v16
    v_lshrrev_b32 v16, 1, v21
    v_xor_b32 v16, v16, v22
    v_lshlrev_b32 v16, 4, v16
    v_lshl_add_u32 v8, v21, 7, v16
    v_add_u32 v8, 2048, v8
    v_xor_b32 v9, 64, v8
    v_add_u32 v10, 65536, v8
    v_add_u32 v11, 65536, v9
    v_add_u32 v12, 131072, v8
    v_add_u32 v13, 131072, v9
    v_lshrrev_b32 v16, 4, v0
    v_lshlrev_b32 v16, 10, v16
    v_lshl_add_u32 v15, v21, 5, v16
    s_mov_b32 s90, 0x00ff00ff
    s_mov_b32 s91, 0x00ff00ff
    s_not_b64 s[92:93], s[90:91]
    s_mov_b32 s94, 0x0f0f0f0f
    s_mov_b32 s95, 0x0f0f0f0f
    s_not_b64 s[96:97], s[94:95]
    s_barrier
    ds_read_b128 v[32:35], v7 offset:0
    ds_read_b128 v[36:39], v7 offset:512
    s_waitcnt vmcnt(6)
    v_cvt_f32_i32 v112, v112
    v_cvt_f32_i32 v113, v113
    s_mul_i32 s59, s41, 9216
    buffer_load_dwordx4 v[128:131], v1, s[20:23], s59 offen
    v_cvt_f32_i32 v114, v114
    v_cvt_f32_i32 v115, v115
    s_waitcnt vmcnt(6)
    v_cvt_f32_i32 v116, v116
    v_cvt_f32_i32 v117, v117
    v_cvt_f32_i32 v118, v118
    buffer_load_dwordx4 v[132:135], v109, s[20:23], s59 offen
    v_cvt_f32_i32 v119, v119
    s_waitcnt vmcnt(6)
    v_cvt_f32_i32 v120, v120
    buffer_load_dwordx4 v[136:139], v110, s[20:23], s59 offen
    v_cvt_f32_i32 v121, v121
    v_cvt_f32_i32 v122, v122
    v_cvt_f32_i32 v123, v123
    buffer_load_dwordx4 v[140:143], v111, s[20:23], s59 offen
    s_waitcnt vmcnt(7)
    v_cvt_f32_i32 v124, v124
    v_cvt_f32_i32 v125, v125
    s_add_u32 s60, s53, 0
    s_cmp_ge_u32 s60, s51
    s_cselect_b32 s58, s52, 0
    s_sub_u32 s60, s60, s58
    s_add_u32 m0, s54, 77824
    s_add_u32 s57, s60, s41
    buffer_load_dwordx4 v2, s[16:19], s57 offen lds
    v_cvt_f32_i32 v126, v126
    v_cvt_f32_i32 v127, v127
    s_waitcnt lgkmcnt(0)
    v_fma_f32 v112, v112, v32, v36
    v_fma_f32 v116, v116, v32, v36
    v_fma_f32 v120, v120, v32, v36
    s_add_u32 s62, s53, 73728
    s_cmp_ge_u32 s62, s51
    s_cselect_b32 s58, s52, 0
    s_sub_u32 s62, s62, s58
    s_add_u32 m0, s54, 86016
    s_add_u32 s57, s62, s41
    buffer_load_dwordx4 v2, s[16:19], s57 offen lds
    v_fma_f32 v124, v124, v32, v36
    v_cvt_pk_bf16_f32 v40, v112, v116
    v_cvt_pk_bf16_f32 v41, v120, v124
    s_add_u32 s64, s53, 147456
    s_cmp_ge_u32 s64, s51
    s_cselect_b32 s58, s52, 0
    s_sub_u32 s64, s64, s58
    s_add_u32 m0, s54, 94208
    s_add_u32 s57, s64, s41
    buffer_load_dwordx4 v2, s[16:19], s57 offen lds
    ds_write_b64 v5, v[40:41] offset:20480
    v_fma_f32 v113, v113, v33, v37
    v_fma_f32 v117, v117, v33, v37
    v_fma_f32 v121, v121, v33, v37
    v_fma_f32 v125, v125, v33, v37
    v_cvt_pk_bf16_f32 v42, v113, v117
    v_cvt_pk_bf16_f32 v43, v121, v125
    ds_write_b64 v5, v[42:43] offset:20992
    v_fma_f32 v114, v114, v34, v38
    v_fma_f32 v118, v118, v34, v38
    v_fma_f32 v122, v122, v34, v38
    v_fma_f32 v126, v126, v34, v38
    v_cvt_pk_bf16_f32 v44, v114, v118
    v_cvt_pk_bf16_f32 v45, v122, v126
    ds_write_b64 v5, v[44:45] offset:21504
    v_fma_f32 v115, v115, v35, v39
    v_fma_f32 v119, v119, v35, v39
    v_fma_f32 v123, v123, v35, v39
    v_fma_f32 v127, v127, v35, v39
    v_cvt_pk_bf16_f32 v46, v115, v119
    v_cvt_pk_bf16_f32 v47, v123, v127
    ds_write_b64 v5, v[46:47] offset:22016
    s_cmp_lg_u32 s56, 4
    s_cbranch_scc1 L_notab
    s_mov_b32 exec_hi, 0
    v_lshlrev_b32 v60, 16, v48
    v_and_b32 v61, 0xffff0000, v48
    v_lshlrev_b32 v68, 16, v52
    v_and_b32 v69, 0xffff0000, v52
    v_lshlrev_b32 v62, 16, v49
    v_and_b32 v63, 0xffff0000, v49
    v_lshlrev_b32 v70, 16, v53
    v_and_b32 v71, 0xffff0000, v53
    v_lshlrev_b32 v64, 16, v50
    v_and_b32 v65, 0xffff0000, v50
    v_lshlrev_b32 v72, 16, v54
    v_and_b32 v73, 0xffff0000, v54
    v_lshlrev_b32 v66, 16, v51
    v_and_b32 v67, 0xffff0000, v51
    v_lshlrev_b32 v74, 16, v55
    v_and_b32 v75, 0xffff0000, v55
    ds_write_b128 v15, v[60:63] offset:0
    ds_write_b128 v15, v[64:67] offset:16
    v_mul_f32 v68, -v68, v60
    v_mul_f32 v69, -v69, v61
    v_mul_f32 v70, -v70, v62
    v_mul_f32 v71, -v71, v63
    v_mul_f32 v72, -v72, v64
    v_mul_f32 v73, -v73, v65
    v_mul_f32 v74, -v74, v66
    v_mul_f32 v75, -v75, v67
    ds_write_b128 v15, v[68:71] offset:512
    ds_write_b128 v15, v[72:75] offset:528
    s_waitcnt lgkmcnt(0)
    s_mov_b32 exec_hi, -1
L_notab:
    s_waitcnt vmcnt(7) lgkmcnt(0)
    s_barrier
    s_setprio 1
    ds_read_b128 v[112:115], v4 offset:20480
    ds_read_b128 v[120:123], v4 offset:28672
    ds_read_b128 v[124:127], v4 offset:29184
    ds_read_b128 v[116:119], v4 offset:20992
    ds_read_b128 v[16:19], v8 offset:53248
    ds_read_b128 v[20:23], v9 offset:53248
    ds_read_b128 v[24:27], v8 offset:57344
    ds_read_b128 v[28:31], v9 offset:57344
    ds_read_b128 v[32:35], v7 offset:2048
    ds_read_b128 v[36:39], v7 offset:2560
    s_waitcnt lgkmcnt(5)
    v_mfma_f32_16x16x32_bf16 v[60:63], v[16:19], v[112:115], 0
    s_waitcnt vmcnt(6)
    v_cvt_f32_i32 v128, v128
    v_cvt_f32_i32 v129, v129
    s_waitcnt lgkmcnt(4)
    v_mfma_f32_16x16x32_bf16 v[60:63], v[20:23], v[120:123], v[60:63]
    s_mul_i32 s59, s42, 9216
    buffer_load_dwordx4 v[144:147], v1, s[20:23], s59 offen
    v_cvt_f32_i32 v130, v130
    v_cvt_f32_i32 v131, v131
    s_waitcnt vmcnt(6)
    v_mfma_f32_16x16x32_bf16 v[64:67], v[20:23], v[124:127], 0
    ds_read_b128 v[20:23], v8 offset:61440
    v_cvt_f32_i32 v132, v132
    v_cvt_f32_i32 v133, v133
    v_mfma_f32_16x16x32_bf16 v[64:67], v[16:19], v[116:119], v[64:67]
    s_setprio 0
    ds_read_b128 v[16:19], v9 offset:61440
    buffer_load_dwordx4 v[148:151], v109, s[20:23], s59 offen
    v_cvt_f32_i32 v134, v134
    v_cvt_f32_i32 v135, v135
    s_waitcnt vmcnt(6)
    s_waitcnt lgkmcnt(5)
    v_mfma_f32_16x16x32_bf16 v[72:75], v[24:27], v[116:119], 0
    v_cvt_f32_i32 v136, v136
    v_cvt_f32_i32 v137, v137
    s_waitcnt lgkmcnt(4)
    v_mfma_f32_16x16x32_bf16 v[72:75], v[28:31], v[124:127], v[72:75]
    v_cvt_f32_i32 v138, v138
    v_cvt_f32_i32 v139, v139
    s_waitcnt vmcnt(5)
    v_mfma_f32_16x16x32_bf16 v[68:71], v[28:31], v[120:123], 0
    ds_read_b128 v[28:31], v10 offset:0
    buffer_load_dwordx4 v[152:155], v110, s[20:23], s59 offen
    v_cvt_f32_i32 v140, v140
    v_cvt_f32_i32 v141, v141
    v_mfma_f32_16x16x32_bf16 v[68:71], v[24:27], v[112:115], v[68:71]
    s_setprio 1
    ds_read_b128 v[24:27], v11 offset:0
    v_cvt_f32_i32 v142, v142
    v_cvt_f32_i32 v143, v143
    s_waitcnt lgkmcnt(4)
    s_waitcnt lgkmcnt(3)
    v_mfma_f32_16x16x32_bf16 v[76:79], v[20:23], v[112:115], 0
    v_fma_f32 v128, v128, v32, v36
    v_fma_f32 v132, v132, v32, v36
    s_waitcnt lgkmcnt(2)
    v_mfma_f32_16x16x32_bf16 v[76:79], v[16:19], v[120:123], v[76:79]
    buffer_load_dwordx4 v[156:159], v111, s[20:23], s59 offen
    v_fma_f32 v136, v136, v32, v36
    v_fma_f32 v140, v140, v32, v36
    v_mfma_f32_16x16x32_bf16 v[80:83], v[16:19], v[124:127], 0
    ds_read_b128 v[16:19], v10 offset:4096
    v_cvt_pk_bf16_f32 v40, v128, v132
    v_cvt_pk_bf16_f32 v41, v136, v140
    ds_write_b64 v5, v[40:41] offset:36864
    v_mfma_f32_16x16x32_bf16 v[80:83], v[20:23], v[116:119], v[80:83]
    s_setprio 0
    ds_read_b128 v[20:23], v11 offset:4096
    s_add_u32 m0, s54, 102400
    s_add_u32 s57, s60, s42
    buffer_load_dwordx4 v2, s[16:19], s57 offen lds
    v_fma_f32 v129, v129, v33, v37
    v_fma_f32 v133, v133, v33, v37
    s_waitcnt lgkmcnt(4)
    v_mfma_f32_16x16x32_bf16 v[88:91], v[28:31], v[116:119], 0
    v_fma_f32 v137, v137, v33, v37
    v_fma_f32 v141, v141, v33, v37
    s_waitcnt lgkmcnt(3)
    v_mfma_f32_16x16x32_bf16 v[88:91], v[24:27], v[124:127], v[88:91]
    v_cvt_pk_bf16_f32 v42, v129, v133
    v_cvt_pk_bf16_f32 v43, v137, v141
    ds_write_b64 v5, v[42:43] offset:37376
    v_mfma_f32_16x16x32_bf16 v[84:87], v[24:27], v[120:123], 0
    ds_read_b128 v[24:27], v10 offset:8192
    s_add_u32 m0, s54, 114688
    s_add_u32 s57, s63, s42
    buffer_load_dwordx4 v2, s[16:19], s57 offen lds
    v_fma_f32 v130, v130, v34, v38
    v_fma_f32 v134, v134, v34, v38
    v_mfma_f32_16x16x32_bf16 v[84:87], v[28:31], v[112:115], v[84:87]
    s_setprio 1
    ds_read_b128 v[28:31], v11 offset:8192
    v_fma_f32 v138, v138, v34, v38
    v_fma_f32 v142, v142, v34, v38
    s_waitcnt lgkmcnt(5)
    v_mfma_f32_16x16x32_bf16 v[92:95], v[16:19], v[112:115], 0
    v_cvt_pk_bf16_f32 v44, v130, v134
    v_cvt_pk_bf16_f32 v45, v138, v142
    ds_write_b64 v5, v[44:45] offset:37888
    s_waitcnt lgkmcnt(4)
    v_mfma_f32_16x16x32_bf16 v[92:95], v[20:23], v[120:123], v[92:95]
    v_fma_f32 v131, v131, v35, v39
    v_fma_f32 v135, v135, v35, v39
    v_fma_f32 v139, v139, v35, v39
    v_fma_f32 v143, v143, v35, v39
    v_cvt_pk_bf16_f32 v46, v131, v135
    v_cvt_pk_bf16_f32 v47, v139, v143
    ds_write_b64 v5, v[46:47] offset:38400
    s_waitcnt vmcnt(6) lgkmcnt(0)
    s_barrier
    s_setprio 1
    v_mfma_f32_16x16x32_bf16 v[96:99], v[20:23], v[124:127], 0
    ds_read_b128 v[20:23], v10 offset:12288
    s_waitcnt vmcnt(5)
    v_cvt_f32_i32 v144, v144
    v_cvt_f32_i32 v145, v145
    v_mfma_f32_16x16x32_bf16 v[96:99], v[16:19], v[116:119], v[96:99]
    ds_read_b128 v[16:19], v11 offset:12288
    ds_read_b128 v[128:131], v4 offset:36864
    s_mul_i32 s59, s43, 9216
    buffer_load_dwordx4 v[160:163], v1, s[20:23], s59 offen
    v_cvt_f32_i32 v146, v146
    v_cvt_f32_i32 v147, v147
    s_waitcnt vmcnt(5)
    v_mfma_f32_16x16x32_bf16 v[104:107], v[24:27], v[116:119], 0
    ds_read_b128 v[136:139], v4 offset:45056
    v_cvt_f32_i32 v148, v148
    v_cvt_f32_i32 v149, v149
    v_mfma_f32_16x16x32_bf16 v[104:107], v[28:31], v[124:127], v[104:107]
    s_setprio 0
    ds_read_b128 v[140:143], v4 offset:45568
    v_cvt_f32_i32 v150, v150
    v_cvt_f32_i32 v151, v151
    s_waitcnt vmcnt(4)
    v_mfma_f32_16x16x32_bf16 v[100:103], v[28:31], v[120:123], 0
    ds_read_b128 v[28:31], v10 offset:16384
    ds_read_b128 v[132:135], v4 offset:37376
    v_cvt_f32_i32 v152, v152
    v_cvt_f32_i32 v153, v153
    v_mfma_f32_16x16x32_bf16 v[100:103], v[24:27], v[112:115], v[100:103]
    ds_read_b128 v[24:27], v11 offset:16384
    ds_read_b128 v[32:35], v7 offset:4096
    ds_read_b128 v[36:39], v7 offset:4608
    buffer_load_dwordx4 v[164:167], v109, s[20:23], s59 offen
    v_cvt_f32_i32 v154, v154
    v_cvt_f32_i32 v155, v155
    s_waitcnt vmcnt(4)
    s_waitcnt lgkmcnt(7)
    v_mfma_f32_16x16x32_bf16 v[60:63], v[20:23], v[128:131], v[60:63]
    v_cvt_f32_i32 v156, v156
    v_cvt_f32_i32 v157, v157
    s_waitcnt lgkmcnt(6)
    v_mfma_f32_16x16x32_bf16 v[60:63], v[16:19], v[136:139], v[60:63]
    s_setprio 1
    v_cvt_f32_i32 v158, v158
    v_cvt_f32_i32 v159, v159
    s_waitcnt lgkmcnt(0)
    v_mfma_f32_16x16x32_bf16 v[64:67], v[16:19], v[140:143], v[64:67]
    ds_read_b128 v[16:19], v10 offset:20480
    v_fma_f32 v144, v144, v32, v36
    v_fma_f32 v148, v148, v32, v36
    v_mfma_f32_16x16x32_bf16 v[64:67], v[20:23], v[132:135], v[64:67]
    ds_read_b128 v[20:23], v11 offset:20480
    buffer_load_dwordx4 v[168:171], v110, s[20:23], s59 offen
    v_fma_f32 v152, v152, v32, v36
    v_fma_f32 v156, v156, v32, v36
    v_mfma_f32_16x16x32_bf16 v[72:75], v[28:31], v[132:135], v[72:75]
    v_cvt_pk_bf16_f32 v40, v144, v148
    v_cvt_pk_bf16_f32 v41, v152, v156
    ds_write_b64 v5, v[40:41] offset:20480
    v_mfma_f32_16x16x32_bf16 v[72:75], v[24:27], v[140:143], v[72:75]
    s_setprio 0
    v_fma_f32 v145, v145, v33, v37
    v_fma_f32 v149, v149, v33, v37
    v_mfma_f32_16x16x32_bf16 v[68:71], v[24:27], v[136:139], v[68:71]
    ds_read_b128 v[24:27], v10 offset:24576
    buffer_load_dwordx4 v[172:175], v111, s[20:23], s59 offen
    v_fma_f32 v153, v153, v33, v37
    v_fma_f32 v157, v157, v33, v37
    v_mfma_f32_16x16x32_bf16 v[68:71], v[28:31], v[128:131], v[68:71]
    ds_read_b128 v[28:31], v11 offset:24576
    v_cvt_pk_bf16_f32 v42, v145, v149
    v_cvt_pk_bf16_f32 v43, v153, v157
    ds_write_b64 v5, v[42:43] offset:20992
    s_waitcnt lgkmcnt(5)
    v_mfma_f32_16x16x32_bf16 v[76:79], v[16:19], v[128:131], v[76:79]
    v_fma_f32 v146, v146, v34, v38
    v_fma_f32 v150, v150, v34, v38
    s_waitcnt lgkmcnt(4)
    v_mfma_f32_16x16x32_bf16 v[76:79], v[20:23], v[136:139], v[76:79]
    s_setprio 1
    v_fma_f32 v154, v154, v34, v38
    v_fma_f32 v158, v158, v34, v38
    v_mfma_f32_16x16x32_bf16 v[80:83], v[20:23], v[140:143], v[80:83]
    ds_read_b128 v[20:23], v10 offset:28672
    s_add_u32 m0, s54, 53248
    s_add_u32 s57, s60, s43
    buffer_load_dwordx4 v2, s[16:19], s57 offen lds
    v_cvt_pk_bf16_f32 v44, v146, v150
    v_cvt_pk_bf16_f32 v45, v154, v158
    ds_write_b64 v5, v[44:45] offset:21504
    v_mfma_f32_16x16x32_bf16 v[80:83], v[16:19], v[132:135], v[80:83]
    ds_read_b128 v[16:19], v11 offset:28672
    v_fma_f32 v147, v147, v35, v39
    v_fma_f32 v151, v151, v35, v39
    s_waitcnt lgkmcnt(5)
    v_mfma_f32_16x16x32_bf16 v[88:91], v[24:27], v[132:135], v[88:91]
    v_fma_f32 v155, v155, v35, v39
    v_fma_f32 v159, v159, v35, v39
    s_waitcnt lgkmcnt(4)
    v_mfma_f32_16x16x32_bf16 v[88:91], v[28:31], v[140:143], v[88:91]
    s_setprio 0
    v_cvt_pk_bf16_f32 v46, v147, v151
    v_cvt_pk_bf16_f32 v47, v155, v159
    ds_write_b64 v5, v[46:47] offset:22016
    v_mfma_f32_16x16x32_bf16 v[84:87], v[28:31], v[136:139], v[84:87]
    ds_read_b128 v[28:31], v10 offset:32768
    s_add_u32 m0, s54, 65536
    s_add_u32 s57, s63, s43
    buffer_load_dwordx4 v2, s[16:19], s57 offen lds
    v_mfma_f32_16x16x32_bf16 v[84:87], v[24:27], v[128:131], v[84:87]
    ds_read_b128 v[24:27], v11 offset:32768
    s_waitcnt lgkmcnt(5)
    v_mfma_f32_16x16x32_bf16 v[92:95], v[20:23], v[128:131], v[92:95]
    s_waitcnt lgkmcnt(3)
    v_mfma_f32_16x16x32_bf16 v[92:95], v[16:19], v[136:139], v[92:95]
    s_setprio 1
    s_waitcnt vmcnt(6) lgkmcnt(2)
    s_barrier
    s_setprio 1
    v_mfma_f32_16x16x32_bf16 v[96:99], v[16:19], v[140:143], v[96:99]
    ds_read_b128 v[16:19], v10 offset:36864
    s_waitcnt vmcnt(5)
    v_cvt_f32_i32 v160, v160
    v_cvt_f32_i32 v161, v161
    v_mfma_f32_16x16x32_bf16 v[96:99], v[20:23], v[132:135], v[96:99]
    ds_read_b128 v[20:23], v11 offset:36864
    ds_read_b128 v[144:147], v4 offset:20480
    s_mul_i32 s59, s44, 9216
    buffer_load_dwordx4 v[176:179], v1, s[20:23], s59 offen
    v_cvt_f32_i32 v162, v162
    v_cvt_f32_i32 v163, v163
    s_waitcnt vmcnt(5)
    s_waitcnt lgkmcnt(4)
    v_mfma_f32_16x16x32_bf16 v[104:107], v[28:31], v[132:135], v[104:107]
    ds_read_b128 v[152:155], v4 offset:28672
    v_cvt_f32_i32 v164, v164
    v_cvt_f32_i32 v165, v165
    s_waitcnt lgkmcnt(4)
    v_mfma_f32_16x16x32_bf16 v[104:107], v[24:27], v[140:143], v[104:107]
    s_setprio 0
    ds_read_b128 v[156:159], v4 offset:29184
    v_cvt_f32_i32 v166, v166
    v_cvt_f32_i32 v167, v167
    s_waitcnt vmcnt(4)
    v_mfma_f32_16x16x32_bf16 v[100:103], v[24:27], v[136:139], v[100:103]
    ds_read_b128 v[24:27], v10 offset:40960
    ds_read_b128 v[148:151], v4 offset:20992
    v_cvt_f32_i32 v168, v168
    v_cvt_f32_i32 v169, v169
    v_mfma_f32_16x16x32_bf16 v[100:103], v[28:31], v[128:131], v[100:103]
    ds_read_b128 v[28:31], v11 offset:40960
    ds_read_b128 v[32:35], v7 offset:6144
    ds_read_b128 v[36:39], v7 offset:6656
    buffer_load_dwordx4 v[180:183], v109, s[20:23], s59 offen
    v_cvt_f32_i32 v170, v170
    v_cvt_f32_i32 v171, v171
    s_waitcnt vmcnt(4)
    s_waitcnt lgkmcnt(7)
    v_mfma_f32_16x16x32_bf16 v[60:63], v[16:19], v[144:147], v[60:63]
    v_cvt_f32_i32 v172, v172
    v_cvt_f32_i32 v173, v173
    s_waitcnt lgkmcnt(6)
    v_mfma_f32_16x16x32_bf16 v[60:63], v[20:23], v[152:155], v[60:63]
    s_setprio 1
    v_cvt_f32_i32 v174, v174
    v_cvt_f32_i32 v175, v175
    s_waitcnt lgkmcnt(0)
    v_mfma_f32_16x16x32_bf16 v[64:67], v[20:23], v[156:159], v[64:67]
    ds_read_b128 v[20:23], v10 offset:45056
    v_fma_f32 v160, v160, v32, v36
    v_fma_f32 v164, v164, v32, v36
    v_mfma_f32_16x16x32_bf16 v[64:67], v[16:19], v[148:151], v[64:67]
    ds_read_b128 v[16:19], v11 offset:45056
    buffer_load_dwordx4 v[184:187], v110, s[20:23], s59 offen
    v_fma_f32 v168, v168, v32, v36
    v_fma_f32 v172, v172, v32, v36
    v_mfma_f32_16x16x32_bf16 v[72:75], v[24:27], v[148:151], v[72:75]
    v_cvt_pk_bf16_f32 v40, v160, v164
    v_cvt_pk_bf16_f32 v41, v168, v172
    ds_write_b64 v5, v[40:41] offset:36864
    v_mfma_f32_16x16x32_bf16 v[72:75], v[28:31], v[156:159], v[72:75]
    s_setprio 0
    v_fma_f32 v161, v161, v33, v37
    v_fma_f32 v165, v165, v33, v37
    v_mfma_f32_16x16x32_bf16 v[68:71], v[28:31], v[152:155], v[68:71]
    ds_read_b128 v[28:31], v10 offset:49152
    buffer_load_dwordx4 v[188:191], v111, s[20:23], s59 offen
    v_fma_f32 v169, v169, v33, v37
    v_fma_f32 v173, v173, v33, v37
    v_mfma_f32_16x16x32_bf16 v[68:71], v[24:27], v[144:147], v[68:71]
    ds_read_b128 v[24:27], v11 offset:49152
    v_cvt_pk_bf16_f32 v42, v161, v165
    v_cvt_pk_bf16_f32 v43, v169, v173
    ds_write_b64 v5, v[42:43] offset:37376
    s_waitcnt lgkmcnt(5)
    v_mfma_f32_16x16x32_bf16 v[76:79], v[20:23], v[144:147], v[76:79]
    v_fma_f32 v162, v162, v34, v38
    v_fma_f32 v166, v166, v34, v38
    s_waitcnt lgkmcnt(4)
    v_mfma_f32_16x16x32_bf16 v[76:79], v[16:19], v[152:155], v[76:79]
    s_setprio 1
    v_fma_f32 v170, v170, v34, v38
    v_fma_f32 v174, v174, v34, v38
    v_mfma_f32_16x16x32_bf16 v[80:83], v[16:19], v[156:159], v[80:83]
    ds_read_b128 v[16:19], v10 offset:53248
    s_add_u32 m0, s54, 69632
    s_add_u32 s57, s60, s44
    buffer_load_dwordx4 v2, s[16:19], s57 offen lds
    v_cvt_pk_bf16_f32 v44, v162, v166
    v_cvt_pk_bf16_f32 v45, v170, v174
    ds_write_b64 v5, v[44:45] offset:37888
    v_mfma_f32_16x16x32_bf16 v[80:83], v[20:23], v[148:151], v[80:83]
    ds_read_b128 v[20:23], v11 offset:53248
    v_fma_f32 v163, v163, v35, v39
    v_fma_f32 v167, v167, v35, v39
    s_waitcnt lgkmcnt(5)
    v_mfma_f32_16x16x32_bf16 v[88:91], v[28:31], v[148:151], v[88:91]
    v_fma_f32 v171, v171, v35, v39
    v_fma_f32 v175, v175, v35, v39
    s_waitcnt lgkmcnt(4)
    v_mfma_f32_16x16x32_bf16 v[88:91], v[24:27], v[156:159], v[88:91]
    s_setprio 0
    v_cvt_pk_bf16_f32 v46, v163, v167
    v_cvt_pk_bf16_f32 v47, v171, v175
    ds_write_b64 v5, v[46:47] offset:38400
    v_mfma_f32_16x16x32_bf16 v[84:87], v[24:27], v[152:155], v[84:87]
    ds_read_b128 v[24:27], v10 offset:57344
    s_add_u32 m0, s54, 81920
    s_add_u32 s57, s63, s44
    buffer_load_dwordx4 v2, s[16:19], s57 offen lds
    v_mfma_f32_16x16x32_bf16 v[84:87], v[28:31], v[144:147], v[84:87]
    ds_read_b128 v[28:31], v11 offset:57344
    s_waitcnt lgkmcnt(5)
    v_mfma_f32_16x16x32_bf16 v[92:95], v[16:19], v[144:147], v[92:95]
    s_waitcnt lgkmcnt(3)
    v_mfma_f32_16x16x32_bf16 v[92:95], v[20:23], v[152:155], v[92:95]
    s_setprio 1
    s_waitcnt vmcnt(6) lgkmcnt(2)
    s_barrier
    s_setprio 1
    v_mfma_f32_16x16x32_bf16 v[96:99], v[20:23], v[156:159], v[96:99]
    ds_read_b128 v[20:23], v8 offset:53248
    s_waitcnt vmcnt(5)
    v_cvt_f32_i32 v176, v176
    v_cvt_f32_i32 v177, v177
    v_mfma_f32_16x16x32_bf16 v[96:99], v[16:19], v[148:151], v[96:99]
    ds_read_b128 v[16:19], v9 offset:53248
    ds_read_b128 v[160:163], v4 offset:36864
    s_mul_i32 s59, s45, 9216
    buffer_load_dwordx4 v[192:195], v1, s[20:23], s59 offen
    v_cvt_f32_i32 v178, v178
    v_cvt_f32_i32 v179, v179
    s_waitcnt vmcnt(5)
    s_waitcnt lgkmcnt(4)
    v_mfma_f32_16x16x32_bf16 v[104:107], v[24:27], v[148:151], v[104:107]
    ds_read_b128 v[168:171], v4 offset:45056
    v_cvt_f32_i32 v180, v180
    v_cvt_f32_i32 v181, v181
    s_waitcnt lgkmcnt(4)
    v_mfma_f32_16x16x32_bf16 v[104:107], v[28:31], v[156:159], v[104:107]
    s_setprio 0
    ds_read_b128 v[172:175], v4 offset:45568
    v_cvt_f32_i32 v182, v182
    v_cvt_f32_i32 v183, v183
    s_waitcnt vmcnt(4)
    v_mfma_f32_16x16x32_bf16 v[100:103], v[28:31], v[152:155], v[100:103]
    ds_read_b128 v[28:31], v8 offset:57344
    ds_read_b128 v[164:167], v4 offset:37376
    v_cvt_f32_i32 v184, v184
    v_cvt_f32_i32 v185, v185
    v_mfma_f32_16x16x32_bf16 v[100:103], v[24:27], v[144:147], v[100:103]
    ds_read_b128 v[24:27], v9 offset:57344
    ds_read_b128 v[32:35], v7 offset:8192
    ds_read_b128 v[36:39], v7 offset:8704
    buffer_load_dwordx4 v[196:199], v109, s[20:23], s59 offen
    v_cvt_f32_i32 v186, v186
    v_cvt_f32_i32 v187, v187
    s_waitcnt vmcnt(4)
    s_waitcnt lgkmcnt(7)
    v_mfma_f32_16x16x32_bf16 v[60:63], v[20:23], v[160:163], v[60:63]
    v_cvt_f32_i32 v188, v188
    v_cvt_f32_i32 v189, v189
    s_waitcnt lgkmcnt(6)
    v_mfma_f32_16x16x32_bf16 v[60:63], v[16:19], v[168:171], v[60:63]
    s_setprio 1
    v_cvt_f32_i32 v190, v190
    v_cvt_f32_i32 v191, v191
    s_waitcnt lgkmcnt(0)
    v_mfma_f32_16x16x32_bf16 v[64:67], v[16:19], v[172:175], v[64:67]
    ds_read_b128 v[16:19], v8 offset:61440
    v_fma_f32 v176, v176, v32, v36
    v_fma_f32 v180, v180, v32, v36
    v_mfma_f32_16x16x32_bf16 v[64:67], v[20:23], v[164:167], v[64:67]
    ds_read_b128 v[20:23], v9 offset:61440
    buffer_load_dwordx4 v[200:203], v110, s[20:23], s59 offen
    v_fma_f32 v184, v184, v32, v36
    v_fma_f32 v188, v188, v32, v36
    v_mfma_f32_16x16x32_bf16 v[72:75], v[28:31], v[164:167], v[72:75]
    v_cvt_pk_bf16_f32 v40, v176, v180
    v_cvt_pk_bf16_f32 v41, v184, v188
    ds_write_b64 v5, v[40:41] offset:20480
    v_mfma_f32_16x16x32_bf16 v[72:75], v[24:27], v[172:175], v[72:75]
    s_setprio 0
    v_fma_f32 v177, v177, v33, v37
    v_fma_f32 v181, v181, v33, v37
    v_mfma_f32_16x16x32_bf16 v[68:71], v[24:27], v[168:171], v[68:71]
    ds_read_b128 v[24:27], v10 offset:0
    buffer_load_dwordx4 v[204:207], v111, s[20:23], s59 offen
    v_fma_f32 v185, v185, v33, v37
    v_fma_f32 v189, v189, v33, v37
    v_mfma_f32_16x16x32_bf16 v[68:71], v[28:31], v[160:163], v[68:71]
    ds_read_b128 v[28:31], v11 offset:0
    v_cvt_pk_bf16_f32 v42, v177, v181
    v_cvt_pk_bf16_f32 v43, v185, v189
    ds_write_b64 v5, v[42:43] offset:20992
    s_waitcnt lgkmcnt(5)
    v_mfma_f32_16x16x32_bf16 v[76:79], v[16:19], v[160:163], v[76:79]
    v_fma_f32 v178, v178, v34, v38
    v_fma_f32 v182, v182, v34, v38
    s_waitcnt lgkmcnt(4)
    v_mfma_f32_16x16x32_bf16 v[76:79], v[20:23], v[168:171], v[76:79]
    s_setprio 1
    v_fma_f32 v186, v186, v34, v38
    v_fma_f32 v190, v190, v34, v38
    v_mfma_f32_16x16x32_bf16 v[80:83], v[20:23], v[172:175], v[80:83]
    ds_read_b128 v[20:23], v10 offset:61440
    s_add_u32 m0, s54, 94208
    s_add_u32 s57, s60, s45
    buffer_load_dwordx4 v2, s[16:19], s57 offen lds
    v_cvt_pk_bf16_f32 v44, v178, v182
    v_cvt_pk_bf16_f32 v45, v186, v190
    ds_write_b64 v5, v[44:45] offset:21504
    v_mfma_f32_16x16x32_bf16 v[80:83], v[16:19], v[164:167], v[80:83]
    ds_read_b128 v[16:19], v11 offset:61440
    v_fma_f32 v179, v179, v35, v39
    v_fma_f32 v183, v183, v35, v39
    s_waitcnt lgkmcnt(5)
    v_mfma_f32_16x16x32_bf16 v[88:91], v[24:27], v[164:167], v[88:91]
    v_fma_f32 v187, v187, v35, v39
    v_fma_f32 v191, v191, v35, v39
    s_waitcnt lgkmcnt(4)
    v_mfma_f32_16x16x32_bf16 v[88:91], v[28:31], v[172:175], v[88:91]
    s_setprio 0
    v_cvt_pk_bf16_f32 v46, v179, v183
    v_cvt_pk_bf16_f32 v47, v187, v191
    ds_write_b64 v5, v[46:47] offset:22016
    v_mfma_f32_16x16x32_bf16 v[84:87], v[28:31], v[168:171], v[84:87]
    ds_read_b128 v[28:31], v12 offset:0
    s_add_u32 m0, s54, 106496
    s_add_u32 s57, s63, s45
    buffer_load_dwordx4 v2, s[16:19], s57 offen lds
    v_mfma_f32_16x16x32_bf16 v[84:87], v[24:27], v[160:163], v[84:87]
    ds_read_b128 v[24:27], v13 offset:0
    s_waitcnt lgkmcnt(5)
    v_mfma_f32_16x16x32_bf16 v[92:95], v[20:23], v[160:163], v[92:95]
    s_waitcnt lgkmcnt(3)
    v_mfma_f32_16x16x32_bf16 v[92:95], v[16:19], v[168:171], v[92:95]
    s_setprio 1
    s_waitcnt vmcnt(6) lgkmcnt(2)
    s_barrier
    s_setprio 1
    v_mfma_f32_16x16x32_bf16 v[96:99], v[16:19], v[172:175], v[96:99]
    ds_read_b128 v[16:19], v10 offset:4096
    s_waitcnt vmcnt(5)
    v_cvt_f32_i32 v192, v192
    v_cvt_f32_i32 v193, v193
    v_mfma_f32_16x16x32_bf16 v[96:99], v[20:23], v[164:167], v[96:99]
    ds_read_b128 v[20:23], v11 offset:4096
    ds_read_b128 v[176:179], v4 offset:20480
    s_mul_i32 s59, s46, 9216
    buffer_load_dwordx4 v[208:211], v1, s[20:23], s59 offen
    v_cvt_f32_i32 v194, v194
    v_cvt_f32_i32 v195, v195
    s_waitcnt vmcnt(5)
    s_waitcnt lgkmcnt(4)
    v_mfma_f32_16x16x32_bf16 v[104:107], v[28:31], v[164:167], v[104:107]
    ds_read_b128 v[184:187], v4 offset:28672
    v_cvt_f32_i32 v196, v196
    v_cvt_f32_i32 v197, v197
    s_waitcnt lgkmcnt(4)
    v_mfma_f32_16x16x32_bf16 v[104:107], v[24:27], v[172:175], v[104:107]
    s_setprio 0
    ds_read_b128 v[188:191], v4 offset:29184
    v_cvt_f32_i32 v198, v198
    v_cvt_f32_i32 v199, v199
    s_waitcnt vmcnt(4)
    v_mfma_f32_16x16x32_bf16 v[100:103], v[24:27], v[168:171], v[100:103]
    ds_read_b128 v[24:27], v10 offset:8192
    ds_read_b128 v[180:183], v4 offset:20992
    v_cvt_f32_i32 v200, v200
    v_cvt_f32_i32 v201, v201
    v_mfma_f32_16x16x32_bf16 v[100:103], v[28:31], v[160:163], v[100:103]
    ds_read_b128 v[28:31], v11 offset:8192
    ds_read_b128 v[32:35], v7 offset:10240
    ds_read_b128 v[36:39], v7 offset:10752
    buffer_load_dwordx4 v[212:215], v109, s[20:23], s59 offen
    v_cvt_f32_i32 v202, v202
    v_cvt_f32_i32 v203, v203
    s_waitcnt vmcnt(4)
    s_waitcnt lgkmcnt(7)
    v_mfma_f32_16x16x32_bf16 v[60:63], v[16:19], v[176:179], v[60:63]
    v_cvt_f32_i32 v204, v204
    v_cvt_f32_i32 v205, v205
    s_waitcnt lgkmcnt(6)
    v_mfma_f32_16x16x32_bf16 v[60:63], v[20:23], v[184:187], v[60:63]
    s_setprio 1
    v_cvt_f32_i32 v206, v206
    v_cvt_f32_i32 v207, v207
    s_waitcnt lgkmcnt(0)
    v_mfma_f32_16x16x32_bf16 v[64:67], v[20:23], v[188:191], v[64:67]
    ds_read_b128 v[20:23], v10 offset:12288
    v_fma_f32 v192, v192, v32, v36
    v_fma_f32 v196, v196, v32, v36
    v_mfma_f32_16x16x32_bf16 v[64:67], v[16:19], v[180:183], v[64:67]
    ds_read_b128 v[16:19], v11 offset:12288
    buffer_load_dwordx4 v[216:219], v110, s[20:23], s59 offen
    v_fma_f32 v200, v200, v32, v36
    v_fma_f32 v204, v204, v32, v36
    v_mfma_f32_16x16x32_bf16 v[72:75], v[24:27], v[180:183], v[72:75]
    v_cvt_pk_bf16_f32 v40, v192, v196
    v_cvt_pk_bf16_f32 v41, v200, v204
    ds_write_b64 v5, v[40:41] offset:36864
    v_mfma_f32_16x16x32_bf16 v[72:75], v[28:31], v[188:191], v[72:75]
    s_setprio 0
    v_fma_f32 v193, v193, v33, v37
    v_fma_f32 v197, v197, v33, v37
    v_mfma_f32_16x16x32_bf16 v[68:71], v[28:31], v[184:187], v[68:71]
    ds_read_b128 v[28:31], v10 offset:16384
    buffer_load_dwordx4 v[220:223], v111, s[20:23], s59 offen
    v_fma_f32 v201, v201, v33, v37
    v_fma_f32 v205, v205, v33, v37
    v_mfma_f32_16x16x32_bf16 v[68:71], v[24:27], v[176:179], v[68:71]
    ds_read_b128 v[24:27], v11 offset:16384
    v_cvt_pk_bf16_f32 v42, v193, v197
    v_cvt_pk_bf16_f32 v43, v201, v205
    ds_write_b64 v5, v[42:43] offset:37376
    s_waitcnt lgkmcnt(5)
    v_mfma_f32_16x16x32_bf16 v[76:79], v[20:23], v[176:179], v[76:79]
    v_fma_f32 v194, v194, v34, v38
    v_fma_f32 v198, v198, v34, v38
    s_waitcnt lgkmcnt(4)
    v_mfma_f32_16x16x32_bf16 v[76:79], v[16:19], v[184:187], v[76:79]
    s_setprio 1
    v_fma_f32 v202, v202, v34, v38
    v_fma_f32 v206, v206, v34, v38
    v_mfma_f32_16x16x32_bf16 v[80:83], v[16:19], v[188:191], v[80:83]
    ds_read_b128 v[16:19], v10 offset:20480
    s_add_u32 m0, s54, 53248
    s_add_u32 s57, s60, s46
    buffer_load_dwordx4 v2, s[16:19], s57 offen lds
    v_cvt_pk_bf16_f32 v44, v194, v198
    v_cvt_pk_bf16_f32 v45, v202, v206
    ds_write_b64 v5, v[44:45] offset:37888
    v_mfma_f32_16x16x32_bf16 v[80:83], v[20:23], v[180:183], v[80:83]
    ds_read_b128 v[20:23], v11 offset:20480
    v_fma_f32 v195, v195, v35, v39
    v_fma_f32 v199, v199, v35, v39
    s_waitcnt lgkmcnt(5)
    v_mfma_f32_16x16x32_bf16 v[88:91], v[28:31], v[180:183], v[88:91]
    v_fma_f32 v203, v203, v35, v39
    v_fma_f32 v207, v207, v35, v39
    s_waitcnt lgkmcnt(4)
    v_mfma_f32_16x16x32_bf16 v[88:91], v[24:27], v[188:191], v[88:91]
    s_setprio 0
    v_cvt_pk_bf16_f32 v46, v195, v199
    v_cvt_pk_bf16_f32 v47, v203, v207
    ds_write_b64 v5, v[46:47] offset:38400
    v_mfma_f32_16x16x32_bf16 v[84:87], v[24:27], v[184:187], v[84:87]
    ds_read_b128 v[24:27], v10 offset:24576
    s_add_u32 m0, s54, 65536
    s_add_u32 s57, s63, s46
    buffer_load_dwordx4 v2, s[16:19], s57 offen lds
    v_mfma_f32_16x16x32_bf16 v[84:87], v[28:31], v[176:179], v[84:87]
    ds_read_b128 v[28:31], v11 offset:24576
    s_waitcnt lgkmcnt(5)
    v_mfma_f32_16x16x32_bf16 v[92:95], v[16:19], v[176:179], v[92:95]
    s_waitcnt lgkmcnt(3)
    v_mfma_f32_16x16x32_bf16 v[92:95], v[20:23], v[184:187], v[92:95]
    s_setprio 1
    s_waitcnt vmcnt(6) lgkmcnt(2)
    s_barrier
    s_setprio 1
    v_mfma_f32_16x16x32_bf16 v[96:99], v[20:23], v[188:191], v[96:99]
    ds_read_b128 v[20:23], v10 offset:28672
    s_waitcnt vmcnt(5)
    v_cvt_f32_i32 v208, v208
    v_cvt_f32_i32 v209, v209
    v_mfma_f32_16x16x32_bf16 v[96:99], v[16:19], v[180:183], v[96:99]
    ds_read_b128 v[16:19], v11 offset:28672
    ds_read_b128 v[192:195], v4 offset:36864
    s_mul_i32 s59, s47, 9216
    buffer_load_dwordx4 v[224:227], v1, s[20:23], s59 offen
    v_cvt_f32_i32 v210, v210
    v_cvt_f32_i32 v211, v211
    s_waitcnt vmcnt(5)
    s_waitcnt lgkmcnt(4)
    v_mfma_f32_16x16x32_bf16 v[104:107], v[24:27], v[180:183], v[104:107]
    ds_read_b128 v[200:203], v4 offset:45056
    v_cvt_f32_i32 v212, v212
    v_cvt_f32_i32 v213, v213
    s_waitcnt lgkmcnt(4)
    v_mfma_f32_16x16x32_bf16 v[104:107], v[28:31], v[188:191], v[104:107]
    s_setprio 0
    ds_read_b128 v[204:207], v4 offset:45568
    v_cvt_f32_i32 v214, v214
    v_cvt_f32_i32 v215, v215
    s_waitcnt vmcnt(4)
    v_mfma_f32_16x16x32_bf16 v[100:103], v[28:31], v[184:187], v[100:103]
    ds_read_b128 v[28:31], v10 offset:32768
    ds_read_b128 v[196:199], v4 offset:37376
    v_cvt_f32_i32 v216, v216
    v_cvt_f32_i32 v217, v217
    v_mfma_f32_16x16x32_bf16 v[100:103], v[24:27], v[176:179], v[100:103]
    ds_read_b128 v[24:27], v11 offset:32768
    ds_read_b128 v[32:35], v7 offset:12288
    ds_read_b128 v[36:39], v7 offset:12800
    buffer_load_dwordx4 v[228:231], v109, s[20:23], s59 offen
    v_cvt_f32_i32 v218, v218
    v_cvt_f32_i32 v219, v219
    s_waitcnt vmcnt(4)
    s_waitcnt lgkmcnt(7)
    v_mfma_f32_16x16x32_bf16 v[60:63], v[20:23], v[192:195], v[60:63]
    v_cvt_f32_i32 v220, v220
    v_cvt_f32_i32 v221, v221
    s_waitcnt lgkmcnt(6)
    v_mfma_f32_16x16x32_bf16 v[60:63], v[16:19], v[200:203], v[60:63]
    s_setprio 1
    v_cvt_f32_i32 v222, v222
    v_cvt_f32_i32 v223, v223
    s_waitcnt lgkmcnt(0)
    v_mfma_f32_16x16x32_bf16 v[64:67], v[16:19], v[204:207], v[64:67]
    ds_read_b128 v[16:19], v10 offset:36864
    v_fma_f32 v208, v208, v32, v36
    v_fma_f32 v212, v212, v32, v36
    v_mfma_f32_16x16x32_bf16 v[64:67], v[20:23], v[196:199], v[64:67]
    ds_read_b128 v[20:23], v11 offset:36864
    buffer_load_dwordx4 v[232:235], v110, s[20:23], s59 offen
    v_fma_f32 v216, v216, v32, v36
    v_fma_f32 v220, v220, v32, v36
    v_mfma_f32_16x16x32_bf16 v[72:75], v[28:31], v[196:199], v[72:75]
    v_cvt_pk_bf16_f32 v40, v208, v212
    v_cvt_pk_bf16_f32 v41, v216, v220
    ds_write_b64 v5, v[40:41] offset:20480
    v_mfma_f32_16x16x32_bf16 v[72:75], v[24:27], v[204:207], v[72:75]
    s_setprio 0
    v_fma_f32 v209, v209, v33, v37
    v_fma_f32 v213, v213, v33, v37
    v_mfma_f32_16x16x32_bf16 v[68:71], v[24:27], v[200:203], v[68:71]
    ds_read_b128 v[24:27], v10 offset:40960
    buffer_load_dwordx4 v[236:239], v111, s[20:23], s59 offen
    v_fma_f32 v217, v217, v33, v37
    v_fma_f32 v221, v221, v33, v37
    v_mfma_f32_16x16x32_bf16 v[68:71], v[28:31], v[192:195], v[68:71]
    ds_read_b128 v[28:31], v11 offset:40960
    v_cvt_pk_bf16_f32 v42, v209, v213
    v_cvt_pk_bf16_f32 v43, v217, v221
    ds_write_b64 v5, v[42:43] offset:20992
    s_waitcnt lgkmcnt(5)
    v_mfma_f32_16x16x32_bf16 v[76:79], v[16:19], v[192:195], v[76:79]
    v_fma_f32 v210, v210, v34, v38
    v_fma_f32 v214, v214, v34, v38
    s_waitcnt lgkmcnt(4)
    v_mfma_f32_16x16x32_bf16 v[76:79], v[20:23], v[200:203], v[76:79]
    s_setprio 1
    v_fma_f32 v218, v218, v34, v38
    v_fma_f32 v222, v222, v34, v38
    v_mfma_f32_16x16x32_bf16 v[80:83], v[20:23], v[204:207], v[80:83]
    ds_read_b128 v[20:23], v10 offset:45056
    s_add_u32 m0, s54, 69632
    s_add_u32 s57, s60, s47
    buffer_load_dwordx4 v2, s[16:19], s57 offen lds
    v_cvt_pk_bf16_f32 v44, v210, v214
    v_cvt_pk_bf16_f32 v45, v218, v222
    ds_write_b64 v5, v[44:45] offset:21504
    v_mfma_f32_16x16x32_bf16 v[80:83], v[16:19], v[196:199], v[80:83]
    ds_read_b128 v[16:19], v11 offset:45056
    v_fma_f32 v211, v211, v35, v39
    v_fma_f32 v215, v215, v35, v39
    s_waitcnt lgkmcnt(5)
    v_mfma_f32_16x16x32_bf16 v[88:91], v[24:27], v[196:199], v[88:91]
    v_fma_f32 v219, v219, v35, v39
    v_fma_f32 v223, v223, v35, v39
    s_waitcnt lgkmcnt(4)
    v_mfma_f32_16x16x32_bf16 v[88:91], v[28:31], v[204:207], v[88:91]
    s_setprio 0
    v_cvt_pk_bf16_f32 v46, v211, v215
    v_cvt_pk_bf16_f32 v47, v219, v223
    ds_write_b64 v5, v[46:47] offset:22016
    v_mfma_f32_16x16x32_bf16 v[84:87], v[28:31], v[200:203], v[84:87]
    ds_read_b128 v[28:31], v10 offset:49152
    s_add_u32 m0, s54, 81920
    s_add_u32 s57, s63, s47
    buffer_load_dwordx4 v2, s[16:19], s57 offen lds
    v_mfma_f32_16x16x32_bf16 v[84:87], v[24:27], v[192:195], v[84:87]
    ds_read_b128 v[24:27], v11 offset:49152
    s_waitcnt lgkmcnt(5)
    v_mfma_f32_16x16x32_bf16 v[92:95], v[20:23], v[192:195], v[92:95]
    s_waitcnt lgkmcnt(3)
    v_mfma_f32_16x16x32_bf16 v[92:95], v[16:19], v[200:203], v[92:95]
    s_setprio 1
    s_waitcnt vmcnt(6) lgkmcnt(2)
    s_barrier
    s_setprio 1
    v_mfma_f32_16x16x32_bf16 v[96:99], v[16:19], v[204:207], v[96:99]
    ds_read_b128 v[16:19], v8 offset:53248
    s_waitcnt vmcnt(5)
    v_cvt_f32_i32 v224, v224
    v_cvt_f32_i32 v225, v225
    v_mfma_f32_16x16x32_bf16 v[96:99], v[20:23], v[196:199], v[96:99]
    ds_read_b128 v[20:23], v9 offset:53248
    ds_read_b128 v[208:211], v4 offset:20480
    s_mul_i32 s59, s48, 9216
    buffer_load_dwordx4 v[240:243], v1, s[20:23], s59 offen
    v_cvt_f32_i32 v226, v226
    v_cvt_f32_i32 v227, v227
    s_waitcnt vmcnt(5)
    s_waitcnt lgkmcnt(4)
    v_mfma_f32_16x16x32_bf16 v[104:107], v[28:31], v[196:199], v[104:107]
    ds_read_b128 v[216:219], v4 offset:28672
    v_cvt_f32_i32 v228, v228
    v_cvt_f32_i32 v229, v229
    s_waitcnt lgkmcnt(4)
    v_mfma_f32_16x16x32_bf16 v[104:107], v[24:27], v[204:207], v[104:107]
    s_setprio 0
    ds_read_b128 v[220:223], v4 offset:29184
    v_cvt_f32_i32 v230, v230
    v_cvt_f32_i32 v231, v231
    s_waitcnt vmcnt(4)
    v_mfma_f32_16x16x32_bf16 v[100:103], v[24:27], v[200:203], v[100:103]
    ds_read_b128 v[24:27], v8 offset:57344
    ds_read_b128 v[212:215], v4 offset:20992
    v_cvt_f32_i32 v232, v232
    v_cvt_f32_i32 v233, v233
    v_mfma_f32_16x16x32_bf16 v[100:103], v[28:31], v[192:195], v[100:103]
    ds_read_b128 v[28:31], v9 offset:57344
    ds_read_b128 v[32:35], v7 offset:14336
    ds_read_b128 v[36:39], v7 offset:14848
    buffer_load_dwordx4 v[244:247], v109, s[20:23], s59 offen
    v_cvt_f32_i32 v234, v234
    v_cvt_f32_i32 v235, v235
    s_waitcnt vmcnt(4)
    s_waitcnt lgkmcnt(7)
    v_mfma_f32_16x16x32_bf16 v[60:63], v[16:19], v[208:211], v[60:63]
    v_cvt_f32_i32 v236, v236
    v_cvt_f32_i32 v237, v237
    s_waitcnt lgkmcnt(6)
    v_mfma_f32_16x16x32_bf16 v[60:63], v[20:23], v[216:219], v[60:63]
    s_setprio 1
    v_cvt_f32_i32 v238, v238
    v_cvt_f32_i32 v239, v239
    s_waitcnt lgkmcnt(0)
    v_mfma_f32_16x16x32_bf16 v[64:67], v[20:23], v[220:223], v[64:67]
    ds_read_b128 v[20:23], v8 offset:61440
    v_fma_f32 v224, v224, v32, v36
    v_fma_f32 v228, v228, v32, v36
    v_mfma_f32_16x16x32_bf16 v[64:67], v[16:19], v[212:215], v[64:67]
    ds_read_b128 v[16:19], v9 offset:61440
    buffer_load_dwordx4 v[248:251], v110, s[20:23], s59 offen
    v_fma_f32 v232, v232, v32, v36
    v_fma_f32 v236, v236, v32, v36
    v_mfma_f32_16x16x32_bf16 v[72:75], v[24:27], v[212:215], v[72:75]
    v_cvt_pk_bf16_f32 v40, v224, v228
    v_cvt_pk_bf16_f32 v41, v232, v236
    ds_write_b64 v5, v[40:41] offset:36864
    v_mfma_f32_16x16x32_bf16 v[72:75], v[28:31], v[220:223], v[72:75]
    s_setprio 0
    v_fma_f32 v225, v225, v33, v37
    v_fma_f32 v229, v229, v33, v37
    v_mfma_f32_16x16x32_bf16 v[68:71], v[28:31], v[216:219], v[68:71]
    ds_read_b128 v[28:31], v10 offset:0
    buffer_load_dwordx4 v[252:255], v111, s[20:23], s59 offen
    v_fma_f32 v233, v233, v33, v37
    v_fma_f32 v237, v237, v33, v37
    v_mfma_f32_16x16x32_bf16 v[68:71], v[24:27], v[208:211], v[68:71]
    ds_read_b128 v[24:27], v11 offset:0
    v_cvt_pk_bf16_f32 v42, v225, v229
    v_cvt_pk_bf16_f32 v43, v233, v237
    ds_write_b64 v5, v[42:43] offset:37376
    s_waitcnt lgkmcnt(5)
    v_mfma_f32_16x16x32_bf16 v[76:79], v[20:23], v[208:211], v[76:79]
    v_fma_f32 v226, v226, v34, v38
    v_fma_f32 v230, v230, v34, v38
    s_waitcnt lgkmcnt(4)
    v_mfma_f32_16x16x32_bf16 v[76:79], v[16:19], v[216:219], v[76:79]
    s_setprio 1
    v_fma_f32 v234, v234, v34, v38
    v_fma_f32 v238, v238, v34, v38
    v_mfma_f32_16x16x32_bf16 v[80:83], v[16:19], v[220:223], v[80:83]
    ds_read_b128 v[16:19], v10 offset:53248
    s_add_u32 m0, s54, 86016
    s_add_u32 s57, s60, s48
    buffer_load_dwordx4 v2, s[16:19], s57 offen lds
    v_cvt_pk_bf16_f32 v44, v226, v230
    v_cvt_pk_bf16_f32 v45, v234, v238
    ds_write_b64 v5, v[44:45] offset:37888
    v_mfma_f32_16x16x32_bf16 v[80:83], v[20:23], v[212:215], v[80:83]
    ds_read_b128 v[20:23], v11 offset:53248
    v_fma_f32 v227, v227, v35, v39
    v_fma_f32 v231, v231, v35, v39
    s_waitcnt lgkmcnt(5)
    v_mfma_f32_16x16x32_bf16 v[88:91], v[28:31], v[212:215], v[88:91]
    v_fma_f32 v235, v235, v35, v39
    v_fma_f32 v239, v239, v35, v39
    s_waitcnt lgkmcnt(4)
    v_mfma_f32_16x16x32_bf16 v[88:91], v[24:27], v[220:223], v[88:91]
    s_setprio 0
    v_cvt_pk_bf16_f32 v46, v227, v231
    v_cvt_pk_bf16_f32 v47, v235, v239
    ds_write_b64 v5, v[46:47] offset:38400
    v_mfma_f32_16x16x32_bf16 v[84:87], v[24:27], v[216:219], v[84:87]
    ds_read_b128 v[24:27], v10 offset:57344
    s_add_u32 m0, s54, 98304
    s_add_u32 s57, s63, s48
    buffer_load_dwordx4 v2, s[16:19], s57 offen lds
    v_mfma_f32_16x16x32_bf16 v[84:87], v[28:31], v[208:211], v[84:87]
    ds_read_b128 v[28:31], v11 offset:57344
    s_waitcnt lgkmcnt(5)
    v_mfma_f32_16x16x32_bf16 v[92:95], v[16:19], v[208:211], v[92:95]
    s_waitcnt lgkmcnt(3)
    v_mfma_f32_16x16x32_bf16 v[92:95], v[20:23], v[216:219], v[92:95]
    s_setprio 1
    s_waitcnt vmcnt(6) lgkmcnt(2)
    s_barrier
    s_setprio 1
    v_mfma_f32_16x16x32_bf16 v[96:99], v[20:23], v[220:223], v[96:99]
    ds_read_b128 v[20:23], v10 offset:4096
    s_waitcnt vmcnt(5)
    v_cvt_f32_i32 v240, v240
    v_cvt_f32_i32 v241, v241
    v_mfma_f32_16x16x32_bf16 v[96:99], v[16:19], v[212:215], v[96:99]
    ds_read_b128 v[16:19], v11 offset:4096
    ds_read_b128 v[224:227], v4 offset:36864
    v_cvt_f32_i32 v242, v242
    v_cvt_f32_i32 v243, v243
    s_waitcnt vmcnt(4)
    s_waitcnt lgkmcnt(4)
    v_mfma_f32_16x16x32_bf16 v[104:107], v[24:27], v[212:215], v[104:107]
    ds_read_b128 v[232:235], v4 offset:45056
    v_cvt_f32_i32 v244, v244
    v_cvt_f32_i32 v245, v245
    s_waitcnt lgkmcnt(4)
    v_mfma_f32_16x16x32_bf16 v[104:107], v[28:31], v[220:223], v[104:107]
    s_setprio 0
    ds_read_b128 v[236:239], v4 offset:45568
    v_cvt_f32_i32 v246, v246
    v_cvt_f32_i32 v247, v247
    s_waitcnt vmcnt(3)
    v_mfma_f32_16x16x32_bf16 v[100:103], v[28:31], v[216:219], v[100:103]
    ds_read_b128 v[28:31], v10 offset:8192
    ds_read_b128 v[228:231], v4 offset:37376
    v_cvt_f32_i32 v248, v248
    v_cvt_f32_i32 v249, v249
    v_mfma_f32_16x16x32_bf16 v[100:103], v[24:27], v[208:211], v[100:103]
    ds_read_b128 v[24:27], v11 offset:8192
    ds_read_b128 v[32:35], v7 offset:16384
    ds_read_b128 v[36:39], v7 offset:16896
    v_cvt_f32_i32 v250, v250
    v_cvt_f32_i32 v251, v251
    s_waitcnt vmcnt(2)
    s_waitcnt lgkmcnt(7)
    v_mfma_f32_16x16x32_bf16 v[60:63], v[20:23], v[224:227], v[60:63]
    v_cvt_f32_i32 v252, v252
    v_cvt_f32_i32 v253, v253
    s_waitcnt lgkmcnt(6)
    v_mfma_f32_16x16x32_bf16 v[60:63], v[16:19], v[232:235], v[60:63]
    s_setprio 1
    v_cvt_f32_i32 v254, v254
    v_cvt_f32_i32 v255, v255
    s_waitcnt lgkmcnt(0)
    v_mfma_f32_16x16x32_bf16 v[64:67], v[16:19], v[236:239], v[64:67]
    ds_read_b128 v[16:19], v10 offset:12288
    v_fma_f32 v240, v240, v32, v36
    v_fma_f32 v244, v244, v32, v36
    v_mfma_f32_16x16x32_bf16 v[64:67], v[20:23], v[228:231], v[64:67]
    ds_read_b128 v[20:23], v11 offset:12288
    v_fma_f32 v248, v248, v32, v36
    v_fma_f32 v252, v252, v32, v36
    v_mfma_f32_16x16x32_bf16 v[72:75], v[28:31], v[228:231], v[72:75]
    v_cvt_pk_bf16_f32 v40, v240, v244
    v_cvt_pk_bf16_f32 v41, v248, v252
    ds_write_b64 v5, v[40:41] offset:20480
    v_mfma_f32_16x16x32_bf16 v[72:75], v[24:27], v[236:239], v[72:75]
    s_setprio 0
    v_fma_f32 v241, v241, v33, v37
    v_fma_f32 v245, v245, v33, v37
    v_mfma_f32_16x16x32_bf16 v[68:71], v[24:27], v[232:235], v[68:71]
    ds_read_b128 v[24:27], v10 offset:16384
    v_fma_f32 v249, v249, v33, v37
    v_fma_f32 v253, v253, v33, v37
    v_mfma_f32_16x16x32_bf16 v[68:71], v[28:31], v[224:227], v[68:71]
    ds_read_b128 v[28:31], v11 offset:16384
    v_cvt_pk_bf16_f32 v42, v241, v245
    v_cvt_pk_bf16_f32 v43, v249, v253
    ds_write_b64 v5, v[42:43] offset:20992
    s_waitcnt lgkmcnt(5)
    v_mfma_f32_16x16x32_bf16 v[76:79], v[16:19], v[224:227], v[76:79]
    v_fma_f32 v242, v242, v34, v38
    v_fma_f32 v246, v246, v34, v38
    s_waitcnt lgkmcnt(4)
    v_mfma_f32_16x16x32_bf16 v[76:79], v[20:23], v[232:235], v[76:79]
    s_setprio 1
    v_fma_f32 v250, v250, v34, v38
    v_fma_f32 v254, v254, v34, v38
    v_mfma_f32_16x16x32_bf16 v[80:83], v[20:23], v[236:239], v[80:83]
    ds_read_b128 v[20:23], v10 offset:61440
    v_cvt_pk_bf16_f32 v44, v242, v246
    v_cvt_pk_bf16_f32 v45, v250, v254
    ds_write_b64 v5, v[44:45] offset:21504
    v_mfma_f32_16x16x32_bf16 v[80:83], v[16:19], v[228:231], v[80:83]
    ds_read_b128 v[16:19], v11 offset:61440
    v_fma_f32 v243, v243, v35, v39
    v_fma_f32 v247, v247, v35, v39
    s_waitcnt lgkmcnt(5)
    v_mfma_f32_16x16x32_bf16 v[88:91], v[24:27], v[228:231], v[88:91]
    v_fma_f32 v251, v251, v35, v39
    v_fma_f32 v255, v255, v35, v39
    s_waitcnt lgkmcnt(4)
    v_mfma_f32_16x16x32_bf16 v[88:91], v[28:31], v[236:239], v[88:91]
    s_setprio 0
    v_cvt_pk_bf16_f32 v46, v243, v247
    v_cvt_pk_bf16_f32 v47, v251, v255
    ds_write_b64 v5, v[46:47] offset:22016
    v_mfma_f32_16x16x32_bf16 v[84:87], v[28:31], v[232:235], v[84:87]
    ds_read_b128 v[28:31], v12 offset:0
    s_add_u32 s66, s53, 221184
    s_cmp_ge_u32 s66, s51
    s_cselect_b32 s58, s52, 0
    s_sub_u32 s66, s66, s58
    s_add_u32 m0, s54, 53248
    s_add_u32 s57, s66, s40
    buffer_load_dwordx4 v2, s[16:19], s57 offen lds
    v_mfma_f32_16x16x32_bf16 v[84:87], v[24:27], v[224:227], v[84:87]
    ds_read_b128 v[24:27], v13 offset:0
    s_waitcnt lgkmcnt(5)
    v_mfma_f32_16x16x32_bf16 v[92:95], v[20:23], v[224:227], v[92:95]
    s_add_u32 m0, s54, 65536
    s_add_u32 s57, s66, s43
    buffer_load_dwordx4 v2, s[16:19], s57 offen lds
    s_waitcnt lgkmcnt(3)
    v_mfma_f32_16x16x32_bf16 v[92:95], v[16:19], v[232:235], v[92:95]
    s_setprio 1
    s_waitcnt vmcnt(2) lgkmcnt(2)
    s_barrier
    s_setprio 1
    v_mfma_f32_16x16x32_bf16 v[96:99], v[16:19], v[236:239], v[96:99]
    ds_read_b128 v[16:19], v10 offset:20480
    v_mfma_f32_16x16x32_bf16 v[96:99], v[20:23], v[228:231], v[96:99]
    ds_read_b128 v[20:23], v11 offset:20480
    ds_read_b128 v[240:243], v4 offset:20480
    s_waitcnt lgkmcnt(4)
    v_mfma_f32_16x16x32_bf16 v[104:107], v[28:31], v[228:231], v[104:107]
    ds_read_b128 v[248:251], v4 offset:28672
    s_waitcnt lgkmcnt(4)
    v_mfma_f32_16x16x32_bf16 v[104:107], v[24:27], v[236:239], v[104:107]
    s_setprio 0
    ds_read_b128 v[252:255], v4 offset:29184
    s_add_u32 m0, s54, 0
    s_add_u32 s57, s66, s44
    buffer_load_dwordx4 v2, s[16:19], s57 offen lds
    v_mfma_f32_16x16x32_bf16 v[100:103], v[24:27], v[232:235], v[100:103]
    ds_read_b128 v[24:27], v10 offset:24576
    ds_read_b128 v[244:247], v4 offset:20992
    v_mfma_f32_16x16x32_bf16 v[100:103], v[28:31], v[224:227], v[100:103]
    ds_read_b128 v[28:31], v11 offset:24576
    s_waitcnt lgkmcnt(5)
    v_mfma_f32_16x16x32_bf16 v[60:63], v[16:19], v[240:243], v[60:63]
    s_waitcnt lgkmcnt(4)
    v_mfma_f32_16x16x32_bf16 v[60:63], v[20:23], v[248:251], v[60:63]
    s_setprio 1
    s_waitcnt lgkmcnt(3)
    v_mfma_f32_16x16x32_bf16 v[64:67], v[20:23], v[252:255], v[64:67]
    ds_read_b128 v[20:23], v10 offset:28672
    s_add_u32 m0, s54, 12288
    s_add_u32 s57, s66, s47
    buffer_load_dwordx4 v2, s[16:19], s57 offen lds
    s_waitcnt lgkmcnt(2)
    v_mfma_f32_16x16x32_bf16 v[64:67], v[16:19], v[244:247], v[64:67]
    ds_read_b128 v[16:19], v11 offset:28672
    v_mfma_f32_16x16x32_bf16 v[72:75], v[24:27], v[244:247], v[72:75]
    s_waitcnt lgkmcnt(2)
    v_mfma_f32_16x16x32_bf16 v[72:75], v[28:31], v[252:255], v[72:75]
    s_setprio 0
    v_mfma_f32_16x16x32_bf16 v[68:71], v[28:31], v[248:251], v[68:71]
    ds_read_b128 v[28:31], v10 offset:32768
    v_mfma_f32_16x16x32_bf16 v[68:71], v[24:27], v[240:243], v[68:71]
    ds_read_b128 v[24:27], v11 offset:32768
    s_waitcnt lgkmcnt(3)
    v_mfma_f32_16x16x32_bf16 v[76:79], v[20:23], v[240:243], v[76:79]
    s_add_u32 s67, s53, 258048
    s_cmp_ge_u32 s67, s51
    s_cselect_b32 s58, s52, 0
    s_sub_u32 s67, s67, s58
    s_add_u32 m0, s54, 40960
    s_add_u32 s57, s67, s41
    buffer_load_dwordx4 v2, s[16:19], s57 offen lds
    s_waitcnt lgkmcnt(2)
    v_mfma_f32_16x16x32_bf16 v[76:79], v[16:19], v[248:251], v[76:79]
    s_setprio 1
    v_mfma_f32_16x16x32_bf16 v[80:83], v[16:19], v[252:255], v[80:83]
    ds_read_b128 v[16:19], v10 offset:36864
    v_mfma_f32_16x16x32_bf16 v[80:83], v[20:23], v[244:247], v[80:83]
    ds_read_b128 v[20:23], v11 offset:36864
    v_cvt_pk_bf16_f32 v48, v60, v64
    s_waitcnt lgkmcnt(3)
    v_mfma_f32_16x16x32_bf16 v[88:91], v[28:31], v[244:247], v[88:91]
    v_cvt_pk_bf16_f32 v49, v61, v65
    s_waitcnt lgkmcnt(2)
    v_mfma_f32_16x16x32_bf16 v[88:91], v[24:27], v[252:255], v[88:91]
    s_setprio 0
    s_add_u32 m0, s54, 69632
    s_add_u32 s57, s67, s44
    buffer_load_dwordx4 v2, s[16:19], s57 offen lds
    v_cvt_pk_bf16_f32 v50, v62, v66
    v_mfma_f32_16x16x32_bf16 v[84:87], v[24:27], v[248:251], v[84:87]
    ds_read_b128 v[24:27], v10 offset:40960
    v_cvt_pk_bf16_f32 v51, v63, v67
    s_mov_b64 vcc, s[90:91]
    s_add_u32 s14, s50, 18432
    v_mfma_f32_16x16x32_bf16 v[84:87], v[28:31], v[240:243], v[84:87]
    ds_read_b128 v[28:31], v11 offset:40960
    v_cndmask_b32_dpp v52, v50, v48, vcc row_ror:8 row_mask:0xf bank_mask:0xf
    s_waitcnt lgkmcnt(3)
    v_mfma_f32_16x16x32_bf16 v[92:95], v[16:19], v[240:243], v[92:95]
    v_cndmask_b32_dpp v53, v51, v49, vcc row_ror:8 row_mask:0xf bank_mask:0xf
    s_mov_b64 vcc, s[92:93]
    s_cmp_ge_u32 s14, s51
    s_cselect_b32 s49, s52, 0
    s_waitcnt lgkmcnt(2)
    v_mfma_f32_16x16x32_bf16 v[92:95], v[20:23], v[248:251], v[92:95]
    s_setprio 1
    v_cndmask_b32_dpp v54, v48, v50, vcc row_ror:8 row_mask:0xf bank_mask:0xf
    s_waitcnt vmcnt(2)
    s_barrier
    s_setprio 1
    v_mfma_f32_16x16x32_bf16 v[96:99], v[20:23], v[252:255], v[96:99]
    ds_read_b128 v[20:23], v8 offset:53248
    v_cndmask_b32_dpp v55, v49, v51, vcc row_ror:8 row_mask:0xf bank_mask:0xf
    s_mov_b64 vcc, s[94:95]
    s_sub_u32 s14, s14, s49
    v_mfma_f32_16x16x32_bf16 v[96:99], v[16:19], v[244:247], v[96:99]
    s_setprio 0
    ds_read_b128 v[16:19], v9 offset:53248
    v_cndmask_b32_dpp v56, v53, v52, vcc row_ror:4 row_mask:0xf bank_mask:0xf
    s_waitcnt lgkmcnt(3)
    v_mfma_f32_16x16x32_bf16 v[104:107], v[24:27], v[244:247], v[104:107]
    v_cndmask_b32_dpp v58, v55, v54, vcc row_ror:4 row_mask:0xf bank_mask:0xf
    s_mov_b64 vcc, s[96:97]
    s_lshl_b32 s14, s14, 3
    s_waitcnt lgkmcnt(2)
    v_mfma_f32_16x16x32_bf16 v[104:107], v[28:31], v[252:255], v[104:107]
    s_setprio 1
    v_cndmask_b32_dpp v57, v52, v53, vcc row_ror:12 row_mask:0xf bank_mask:0xf
    v_mfma_f32_16x16x32_bf16 v[100:103], v[28:31], v[248:251], v[100:103]
    ds_read_b128 v[28:31], v8 offset:57344
    v_cndmask_b32_dpp v59, v54, v55, vcc row_ror:12 row_mask:0xf bank_mask:0xf
    buffer_store_dwordx4 v[56:59], v3, s[32:35], s14 offen nt
    v_mfma_f32_16x16x32_bf16 v[100:103], v[24:27], v[240:243], v[100:103]
    s_setprio 0
    ds_read_b128 v[24:27], v9 offset:57344
    s_add_u32 m0, s54, 24576
    s_add_u32 s57, s67, s48
    buffer_load_dwordx4 v2, s[16:19], s57 offen lds
    v_cvt_pk_bf16_f32 v48, v68, v72
    s_waitcnt lgkmcnt(3)
    v_mfma_f32_16x16x32_bf16 v[32:35], v[20:23], v[112:115], 0
    v_cvt_pk_bf16_f32 v49, v69, v73
    s_waitcnt lgkmcnt(2)
    v_mfma_f32_16x16x32_bf16 v[32:35], v[16:19], v[120:123], v[32:35]
    s_setprio 1
    v_cvt_pk_bf16_f32 v50, v70, v74
    v_mfma_f32_16x16x32_bf16 v[36:39], v[16:19], v[124:127], 0
    ds_read_b128 v[16:19], v8 offset:61440
    v_cvt_pk_bf16_f32 v51, v71, v75
    s_mov_b64 vcc, s[90:91]
    s_add_u32 s14, s50, 55296
    v_mfma_f32_16x16x32_bf16 v[36:39], v[20:23], v[116:119], v[36:39]
    s_setprio 0
    ds_read_b128 v[20:23], v9 offset:61440
    v_cndmask_b32_dpp v52, v50, v48, vcc row_ror:8 row_mask:0xf bank_mask:0xf
    s_waitcnt lgkmcnt(3)
    v_mfma_f32_16x16x32_bf16 v[36:39], v[28:31], v[132:135], v[36:39]
    v_cndmask_b32_dpp v53, v51, v49, vcc row_ror:8 row_mask:0xf bank_mask:0xf
    s_mov_b64 vcc, s[92:93]
    s_cmp_ge_u32 s14, s51
    s_cselect_b32 s49, s52, 0
    s_waitcnt lgkmcnt(2)
    v_mfma_f32_16x16x32_bf16 v[36:39], v[24:27], v[140:143], v[36:39]
    s_setprio 1
    v_cndmask_b32_dpp v54, v48, v50, vcc row_ror:8 row_mask:0xf bank_mask:0xf
    v_mfma_f32_16x16x32_bf16 v[32:35], v[24:27], v[136:139], v[32:35]
    ds_read_b128 v[24:27], v10 offset:0
    v_cndmask_b32_dpp v55, v49, v51, vcc row_ror:8 row_mask:0xf bank_mask:0xf
    s_mov_b64 vcc, s[94:95]
    s_sub_u32 s14, s14, s49
    v_mfma_f32_16x16x32_bf16 v[32:35], v[28:31], v[128:131], v[32:35]
    s_setprio 0
    ds_read_b128 v[28:31], v11 offset:0
    s_add_u32 s68, s53, 294912
    s_cmp_ge_u32 s68, s51
    s_cselect_b32 s58, s52, 0
    s_sub_u32 s68, s68, s58
    s_add_u32 m0, s54, 32768
    s_add_u32 s57, s68, s41
    buffer_load_dwordx4 v2, s[16:19], s57 offen lds
    v_cndmask_b32_dpp v56, v53, v52, vcc row_ror:4 row_mask:0xf bank_mask:0xf
    s_waitcnt lgkmcnt(3)
    v_mfma_f32_16x16x32_bf16 v[32:35], v[16:19], v[144:147], v[32:35]
    v_cndmask_b32_dpp v58, v55, v54, vcc row_ror:4 row_mask:0xf bank_mask:0xf
    s_mov_b64 vcc, s[96:97]
    s_lshl_b32 s14, s14, 3
    s_waitcnt lgkmcnt(2)
    v_mfma_f32_16x16x32_bf16 v[32:35], v[20:23], v[152:155], v[32:35]
    s_setprio 1
    v_cndmask_b32_dpp v57, v52, v53, vcc row_ror:12 row_mask:0xf bank_mask:0xf
    v_mfma_f32_16x16x32_bf16 v[36:39], v[20:23], v[156:159], v[36:39]
    ds_read_b128 v[20:23], v8 offset:0
    v_cndmask_b32_dpp v59, v54, v55, vcc row_ror:12 row_mask:0xf bank_mask:0xf
    buffer_store_dwordx4 v[56:59], v3, s[32:35], s14 offen nt
    v_mfma_f32_16x16x32_bf16 v[36:39], v[16:19], v[148:151], v[36:39]
    s_setprio 0
    ds_read_b128 v[16:19], v9 offset:0
    v_cvt_pk_bf16_f32 v48, v76, v80
    s_waitcnt lgkmcnt(3)
    v_mfma_f32_16x16x32_bf16 v[36:39], v[24:27], v[164:167], v[36:39]
    v_cvt_pk_bf16_f32 v49, v77, v81
    s_waitcnt lgkmcnt(2)
    v_mfma_f32_16x16x32_bf16 v[36:39], v[28:31], v[172:175], v[36:39]
    s_setprio 1
    v_cvt_pk_bf16_f32 v50, v78, v82
    v_mfma_f32_16x16x32_bf16 v[32:35], v[28:31], v[168:171], v[32:35]
    ds_read_b128 v[28:31], v8 offset:4096
    v_cvt_pk_bf16_f32 v51, v79, v83
    s_mov_b64 vcc, s[90:91]
    s_add_u32 s14, s50, 92160
    v_mfma_f32_16x16x32_bf16 v[32:35], v[24:27], v[160:163], v[32:35]
    s_setprio 0
    ds_read_b128 v[24:27], v9 offset:4096
    v_cndmask_b32_dpp v52, v50, v48, vcc row_ror:8 row_mask:0xf bank_mask:0xf
    s_waitcnt lgkmcnt(3)
    v_mfma_f32_16x16x32_bf16 v[32:35], v[20:23], v[176:179], v[32:35]
    s_add_u32 m0, s54, 86016
    s_add_u32 s57, s68, s43
    buffer_load_dwordx4 v2, s[16:19], s57 offen lds
    v_cndmask_b32_dpp v53, v51, v49, vcc row_ror:8 row_mask:0xf bank_mask:0xf
    s_mov_b64 vcc, s[92:93]
    s_cmp_ge_u32 s14, s51
    s_cselect_b32 s49, s52, 0
    s_waitcnt lgkmcnt(2)
    v_mfma_f32_16x16x32_bf16 v[32:35], v[16:19], v[184:187], v[32:35]
    s_setprio 1
    v_cndmask_b32_dpp v54, v48, v50, vcc row_ror:8 row_mask:0xf bank_mask:0xf
    v_mfma_f32_16x16x32_bf16 v[36:39], v[16:19], v[188:191], v[36:39]
    ds_read_b128 v[16:19], v8 offset:8192
    v_cndmask_b32_dpp v55, v49, v51, vcc row_ror:8 row_mask:0xf bank_mask:0xf
    s_mov_b64 vcc, s[94:95]
    s_sub_u32 s14, s14, s49
    v_mfma_f32_16x16x32_bf16 v[36:39], v[20:23], v[180:183], v[36:39]
    s_setprio 0
    ds_read_b128 v[20:23], v9 offset:8192
    v_cndmask_b32_dpp v56, v53, v52, vcc row_ror:4 row_mask:0xf bank_mask:0xf
    s_waitcnt lgkmcnt(3)
    v_mfma_f32_16x16x32_bf16 v[36:39], v[28:31], v[196:199], v[36:39]
    v_cndmask_b32_dpp v58, v55, v54, vcc row_ror:4 row_mask:0xf bank_mask:0xf
    s_mov_b64 vcc, s[96:97]
    s_lshl_b32 s14, s14, 3
    s_waitcnt lgkmcnt(2)
    v_mfma_f32_16x16x32_bf16 v[36:39], v[24:27], v[204:207], v[36:39]
    s_setprio 1
    v_cndmask_b32_dpp v57, v52, v53, vcc row_ror:12 row_mask:0xf bank_mask:0xf
    v_mfma_f32_16x16x32_bf16 v[32:35], v[24:27], v[200:203], v[32:35]
    ds_read_b128 v[24:27], v8 offset:12288
    v_cndmask_b32_dpp v59, v54, v55, vcc row_ror:12 row_mask:0xf bank_mask:0xf
    buffer_store_dwordx4 v[56:59], v3, s[32:35], s14 offen nt
    v_mfma_f32_16x16x32_bf16 v[32:35], v[28:31], v[192:195], v[32:35]
    s_setprio 0
    ds_read_b128 v[28:31], v9 offset:12288
    v_cvt_pk_bf16_f32 v48, v84, v88
    s_waitcnt lgkmcnt(3)
    v_mfma_f32_16x16x32_bf16 v[32:35], v[16:19], v[208:211], v[32:35]
    s_add_u32 m0, s54, 94208
    s_add_u32 s57, s68, s45
    buffer_load_dwordx4 v2, s[16:19], s57 offen lds
    v_cvt_pk_bf16_f32 v49, v85, v89
    s_waitcnt lgkmcnt(2)
    v_mfma_f32_16x16x32_bf16 v[32:35], v[20:23], v[216:219], v[32:35]
    s_setprio 1
    v_cvt_pk_bf16_f32 v50, v86, v90
    v_mfma_f32_16x16x32_bf16 v[36:39], v[20:23], v[220:223], v[36:39]
    ds_read_b128 v[20:23], v8 offset:16384
    v_cvt_pk_bf16_f32 v51, v87, v91
    s_mov_b64 vcc, s[90:91]
    s_add_u32 s14, s50, 129024
    v_mfma_f32_16x16x32_bf16 v[36:39], v[16:19], v[212:215], v[36:39]
    s_setprio 0
    ds_read_b128 v[16:19], v9 offset:16384
    v_cndmask_b32_dpp v52, v50, v48, vcc row_ror:8 row_mask:0xf bank_mask:0xf
    s_waitcnt lgkmcnt(3)
    v_mfma_f32_16x16x32_bf16 v[36:39], v[24:27], v[228:231], v[36:39]
    v_cndmask_b32_dpp v53, v51, v49, vcc row_ror:8 row_mask:0xf bank_mask:0xf
    s_mov_b64 vcc, s[92:93]
    s_cmp_ge_u32 s14, s51
    s_cselect_b32 s49, s52, 0
    s_waitcnt lgkmcnt(2)
    v_mfma_f32_16x16x32_bf16 v[36:39], v[28:31], v[236:239], v[36:39]
    s_setprio 1
    v_cndmask_b32_dpp v54, v48, v50, vcc row_ror:8 row_mask:0xf bank_mask:0xf
    s_waitcnt vmcnt(5)
    s_barrier
    s_setprio 1
    v_mfma_f32_16x16x32_bf16 v[32:35], v[28:31], v[232:235], v[32:35]
    ds_read_b128 v[28:31], v8 offset:36864
    v_cndmask_b32_dpp v55, v49, v51, vcc row_ror:8 row_mask:0xf bank_mask:0xf
    s_mov_b64 vcc, s[94:95]
    s_sub_u32 s14, s14, s49
    v_mfma_f32_16x16x32_bf16 v[32:35], v[24:27], v[224:227], v[32:35]
    s_setprio 0
    ds_read_b128 v[24:27], v9 offset:36864
    v_cndmask_b32_dpp v56, v53, v52, vcc row_ror:4 row_mask:0xf bank_mask:0xf
    s_waitcnt lgkmcnt(3)
    v_mfma_f32_16x16x32_bf16 v[32:35], v[20:23], v[240:243], v[32:35]
    v_cndmask_b32_dpp v58, v55, v54, vcc row_ror:4 row_mask:0xf bank_mask:0xf
    s_mov_b64 vcc, s[96:97]
    s_lshl_b32 s14, s14, 3
    s_waitcnt lgkmcnt(2)
    v_mfma_f32_16x16x32_bf16 v[32:35], v[16:19], v[248:251], v[32:35]
    s_setprio 1
    v_cndmask_b32_dpp v57, v52, v53, vcc row_ror:12 row_mask:0xf bank_mask:0xf
    v_mfma_f32_16x16x32_bf16 v[36:39], v[16:19], v[252:255], v[36:39]
    ds_read_b128 v[16:19], v8 offset:40960
    s_add_u32 m0, s54, 0
    s_add_u32 s57, s68, s47
    buffer_load_dwordx4 v2, s[16:19], s57 offen lds
    v_cndmask_b32_dpp v59, v54, v55, vcc row_ror:12 row_mask:0xf bank_mask:0xf
    buffer_store_dwordx4 v[56:59], v3, s[32:35], s14 offen nt
    v_mfma_f32_16x16x32_bf16 v[36:39], v[20:23], v[244:247], v[36:39]
    s_setprio 0
    ds_read_b128 v[20:23], v9 offset:40960
    v_cvt_pk_bf16_f32 v48, v92, v96
    s_waitcnt lgkmcnt(3)
    v_mfma_f32_16x16x32_bf16 v[44:47], v[28:31], v[116:119], 0
    v_cvt_pk_bf16_f32 v49, v93, v97
    s_waitcnt lgkmcnt(2)
    v_mfma_f32_16x16x32_bf16 v[44:47], v[24:27], v[124:127], v[44:47]
    s_setprio 1
    v_cvt_pk_bf16_f32 v50, v94, v98
    v_mfma_f32_16x16x32_bf16 v[40:43], v[24:27], v[120:123], 0
    ds_read_b128 v[24:27], v8 offset:45056
    v_cvt_pk_bf16_f32 v51, v95, v99
    s_mov_b64 vcc, s[90:91]
    s_add_u32 s14, s50, 165888
    v_mfma_f32_16x16x32_bf16 v[40:43], v[28:31], v[112:115], v[40:43]
    s_setprio 0
    ds_read_b128 v[28:31], v9 offset:45056
    v_cndmask_b32_dpp v52, v50, v48, vcc row_ror:8 row_mask:0xf bank_mask:0xf
    s_waitcnt lgkmcnt(3)
    v_mfma_f32_16x16x32_bf16 v[40:43], v[16:19], v[128:131], v[40:43]
    s_add_u32 s69, s53, 331776
    s_cmp_ge_u32 s69, s51
    s_cselect_b32 s58, s52, 0
    s_sub_u32 s69, s69, s58
    s_add_u32 s58, s99, 18
    s_cmp_ge_u32 s58, s55
    s_cselect_b32 s69, 0x40000000, s69
    s_add_u32 m0, s54, 8192
    s_add_u32 s57, s69, s40
    buffer_load_dwordx4 v2, s[16:19], s57 offen lds
    v_cndmask_b32_dpp v53, v51, v49, vcc row_ror:8 row_mask:0xf bank_mask:0xf
    s_mov_b64 vcc, s[92:93]
    s_cmp_ge_u32 s14, s51
    s_cselect_b32 s49, s52, 0
    s_waitcnt lgkmcnt(2)
    v_mfma_f32_16x16x32_bf16 v[40:43], v[20:23], v[136:139], v[40:43]
    s_setprio 1
    v_cndmask_b32_dpp v54, v48, v50, vcc row_ror:8 row_mask:0xf bank_mask:0xf
    v_mfma_f32_16x16x32_bf16 v[44:47], v[20:23], v[140:143], v[44:47]
    ds_read_b128 v[20:23], v8 offset:49152
    v_cndmask_b32_dpp v55, v49, v51, vcc row_ror:8 row_mask:0xf bank_mask:0xf
    s_mov_b64 vcc, s[94:95]
    s_sub_u32 s14, s14, s49
    v_mfma_f32_16x16x32_bf16 v[44:47], v[16:19], v[132:135], v[44:47]
    s_setprio 0
    ds_read_b128 v[16:19], v9 offset:49152
    v_cndmask_b32_dpp v56, v53, v52, vcc row_ror:4 row_mask:0xf bank_mask:0xf
    s_waitcnt lgkmcnt(3)
    v_mfma_f32_16x16x32_bf16 v[44:47], v[24:27], v[148:151], v[44:47]
    v_cndmask_b32_dpp v58, v55, v54, vcc row_ror:4 row_mask:0xf bank_mask:0xf
    s_mov_b64 vcc, s[96:97]
    s_lshl_b32 s14, s14, 3
    s_waitcnt lgkmcnt(2)
    v_mfma_f32_16x16x32_bf16 v[44:47], v[28:31], v[156:159], v[44:47]
    s_setprio 1
    v_cndmask_b32_dpp v57, v52, v53, vcc row_ror:12 row_mask:0xf bank_mask:0xf
    v_mfma_f32_16x16x32_bf16 v[40:43], v[28:31], v[152:155], v[40:43]
    ds_read_b128 v[28:31], v10 offset:4096
    v_cndmask_b32_dpp v59, v54, v55, vcc row_ror:12 row_mask:0xf bank_mask:0xf
    buffer_store_dwordx4 v[56:59], v3, s[32:35], s14 offen nt
    v_mfma_f32_16x16x32_bf16 v[40:43], v[24:27], v[144:147], v[40:43]
    s_setprio 0
    ds_read_b128 v[24:27], v11 offset:4096
    s_add_u32 m0, s54, 57344
    s_add_u32 s57, s69, s42
    buffer_load_dwordx4 v2, s[16:19], s57 offen lds
    v_cvt_pk_bf16_f32 v48, v100, v104
    s_waitcnt lgkmcnt(3)
    v_mfma_f32_16x16x32_bf16 v[40:43], v[20:23], v[160:163], v[40:43]
    v_cvt_pk_bf16_f32 v49, v101, v105
    s_waitcnt lgkmcnt(2)
    v_mfma_f32_16x16x32_bf16 v[40:43], v[16:19], v[168:171], v[40:43]
    s_setprio 1
    v_cvt_pk_bf16_f32 v50, v102, v106
    v_mfma_f32_16x16x32_bf16 v[44:47], v[16:19], v[172:175], v[44:47]
    ds_read_b128 v[16:19], v10 offset:8192
    v_cvt_pk_bf16_f32 v51, v103, v107
    s_mov_b64 vcc, s[90:91]
    s_add_u32 s14, s50, 202752
    v_mfma_f32_16x16x32_bf16 v[44:47], v[20:23], v[164:167], v[44:47]
    s_setprio 0
    ds_read_b128 v[20:23], v11 offset:8192
    v_cndmask_b32_dpp v52, v50, v48, vcc row_ror:8 row_mask:0xf bank_mask:0xf
    s_waitcnt lgkmcnt(3)
    v_mfma_f32_16x16x32_bf16 v[44:47], v[28:31], v[180:183], v[44:47]
    v_cndmask_b32_dpp v53, v51, v49, vcc row_ror:8 row_mask:0xf bank_mask:0xf
    s_mov_b64 vcc, s[92:93]
    s_cmp_ge_u32 s14, s51
    s_cselect_b32 s49, s52, 0
    s_waitcnt lgkmcnt(2)
    v_mfma_f32_16x16x32_bf16 v[44:47], v[24:27], v[188:191], v[44:47]
    s_setprio 1
    v_cndmask_b32_dpp v54, v48, v50, vcc row_ror:8 row_mask:0xf bank_mask:0xf
    v_mfma_f32_16x16x32_bf16 v[40:43], v[24:27], v[184:187], v[40:43]
    ds_read_b128 v[24:27], v10 offset:12288
    s_add_u32 m0, s54, 65536
    s_add_u32 s57, s69, s44
    buffer_load_dwordx4 v2, s[16:19], s57 offen lds
    v_cndmask_b32_dpp v55, v49, v51, vcc row_ror:8 row_mask:0xf bank_mask:0xf
    s_mov_b64 vcc, s[94:95]
    s_sub_u32 s14, s14, s49
    v_mfma_f32_16x16x32_bf16 v[40:43], v[28:31], v[176:179], v[40:43]
    s_setprio 0
    ds_read_b128 v[28:31], v11 offset:12288
    v_cndmask_b32_dpp v56, v53, v52, vcc row_ror:4 row_mask:0xf bank_mask:0xf
    s_waitcnt lgkmcnt(3)
    v_mfma_f32_16x16x32_bf16 v[40:43], v[16:19], v[192:195], v[40:43]
    v_cndmask_b32_dpp v58, v55, v54, vcc row_ror:4 row_mask:0xf bank_mask:0xf
    s_mov_b64 vcc, s[96:97]
    s_lshl_b32 s14, s14, 3
    s_waitcnt lgkmcnt(2)
    v_mfma_f32_16x16x32_bf16 v[40:43], v[20:23], v[200:203], v[40:43]
    s_setprio 1
    v_cndmask_b32_dpp v57, v52, v53, vcc row_ror:12 row_mask:0xf bank_mask:0xf
    v_mfma_f32_16x16x32_bf16 v[44:47], v[20:23], v[204:207], v[44:47]
    ds_read_b128 v[20:23], v8 offset:20480
    v_cndmask_b32_dpp v59, v54, v55, vcc row_ror:12 row_mask:0xf bank_mask:0xf
    buffer_store_dwordx4 v[56:59], v3, s[32:35], s14 offen nt
    v_mfma_f32_16x16x32_bf16 v[44:47], v[16:19], v[196:199], v[44:47]
    s_setprio 0
    ds_read_b128 v[16:19], v9 offset:20480
    v_cvt_pk_bf16_f32 v48, v32, v36
    s_waitcnt lgkmcnt(3)
    v_mfma_f32_16x16x32_bf16 v[44:47], v[24:27], v[212:215], v[44:47]
    v_cvt_pk_bf16_f32 v49, v33, v37
    s_waitcnt lgkmcnt(2)
    v_mfma_f32_16x16x32_bf16 v[44:47], v[28:31], v[220:223], v[44:47]
    s_setprio 1
    s_add_u32 m0, s54, 106496
    s_add_u32 s57, s69, s46
    buffer_load_dwordx4 v2, s[16:19], s57 offen lds
    v_cvt_pk_bf16_f32 v50, v34, v38
    v_mfma_f32_16x16x32_bf16 v[40:43], v[28:31], v[216:219], v[40:43]
    ds_read_b128 v[28:31], v8 offset:24576
    v_cvt_pk_bf16_f32 v51, v35, v39
    s_mov_b64 vcc, s[90:91]
    s_add_u32 s14, s50, 239616
    v_mfma_f32_16x16x32_bf16 v[40:43], v[24:27], v[208:211], v[40:43]
    s_setprio 0
    ds_read_b128 v[24:27], v9 offset:24576
    v_cndmask_b32_dpp v52, v50, v48, vcc row_ror:8 row_mask:0xf bank_mask:0xf
    s_waitcnt lgkmcnt(3)
    v_mfma_f32_16x16x32_bf16 v[40:43], v[20:23], v[224:227], v[40:43]
    v_cndmask_b32_dpp v53, v51, v49, vcc row_ror:8 row_mask:0xf bank_mask:0xf
    s_mov_b64 vcc, s[92:93]
    s_cmp_ge_u32 s14, s51
    s_cselect_b32 s49, s52, 0
    s_waitcnt lgkmcnt(2)
    v_mfma_f32_16x16x32_bf16 v[40:43], v[16:19], v[232:235], v[40:43]
    s_setprio 1
    v_cndmask_b32_dpp v54, v48, v50, vcc row_ror:8 row_mask:0xf bank_mask:0xf
    s_waitcnt vmcnt(7)
    s_barrier
    s_setprio 1
    v_mfma_f32_16x16x32_bf16 v[44:47], v[16:19], v[236:239], v[44:47]
    ds_read_b128 v[16:19], v8 offset:28672
    v_cndmask_b32_dpp v55, v49, v51, vcc row_ror:8 row_mask:0xf bank_mask:0xf
    s_mov_b64 vcc, s[94:95]
    s_sub_u32 s14, s14, s49
    v_mfma_f32_16x16x32_bf16 v[44:47], v[20:23], v[228:231], v[44:47]
    s_setprio 0
    ds_read_b128 v[20:23], v9 offset:28672
    v_cndmask_b32_dpp v56, v53, v52, vcc row_ror:4 row_mask:0xf bank_mask:0xf
    s_waitcnt lgkmcnt(3)
    v_mfma_f32_16x16x32_bf16 v[44:47], v[28:31], v[244:247], v[44:47]
    v_cndmask_b32_dpp v58, v55, v54, vcc row_ror:4 row_mask:0xf bank_mask:0xf
    s_mov_b64 vcc, s[96:97]
    s_lshl_b32 s14, s14, 3
    s_waitcnt lgkmcnt(2)
    v_mfma_f32_16x16x32_bf16 v[44:47], v[24:27], v[252:255], v[44:47]
    s_setprio 1
    v_cndmask_b32_dpp v57, v52, v53, vcc row_ror:12 row_mask:0xf bank_mask:0xf
    v_mfma_f32_16x16x32_bf16 v[40:43], v[24:27], v[248:251], v[40:43]
    ds_read_b128 v[24:27], v8 offset:32768
    v_cndmask_b32_dpp v59, v54, v55, vcc row_ror:12 row_mask:0xf bank_mask:0xf
    buffer_store_dwordx4 v[56:59], v3, s[32:35], s14 offen nt
    v_mfma_f32_16x16x32_bf16 v[40:43], v[28:31], v[240:243], v[40:43]
    s_setprio 0
    ds_read_b128 v[28:31], v9 offset:32768
    s_waitcnt lgkmcnt(3)
    v_mfma_f32_16x16x32_bf16 v[32:35], v[16:19], v[112:115], 0
    s_waitcnt lgkmcnt(2)
    v_mfma_f32_16x16x32_bf16 v[32:35], v[20:23], v[120:123], v[32:35]
    s_setprio 1
    v_mfma_f32_16x16x32_bf16 v[36:39], v[20:23], v[124:127], 0
    ds_read_b128 v[20:23], v10 offset:16384
    v_mfma_f32_16x16x32_bf16 v[36:39], v[16:19], v[116:119], v[36:39]
    s_setprio 0
    ds_read_b128 v[16:19], v11 offset:16384
    s_waitcnt lgkmcnt(3)
    v_mfma_f32_16x16x32_bf16 v[36:39], v[24:27], v[132:135], v[36:39]
    s_waitcnt lgkmcnt(2)
    v_mfma_f32_16x16x32_bf16 v[36:39], v[28:31], v[140:143], v[36:39]
    s_setprio 1
    v_mfma_f32_16x16x32_bf16 v[32:35], v[28:31], v[136:139], v[32:35]
    ds_read_b128 v[28:31], v10 offset:20480
    v_mfma_f32_16x16x32_bf16 v[32:35], v[24:27], v[128:131], v[32:35]
    s_setprio 0
    ds_read_b128 v[24:27], v11 offset:20480
    v_cvt_pk_bf16_f32 v48, v40, v44
    s_waitcnt lgkmcnt(3)
    v_mfma_f32_16x16x32_bf16 v[32:35], v[20:23], v[144:147], v[32:35]
    v_cvt_pk_bf16_f32 v49, v41, v45
    s_waitcnt lgkmcnt(2)
    v_mfma_f32_16x16x32_bf16 v[32:35], v[16:19], v[152:155], v[32:35]
    s_setprio 1
    v_cvt_pk_bf16_f32 v50, v42, v46
    v_mfma_f32_16x16x32_bf16 v[36:39], v[16:19], v[156:159], v[36:39]
    ds_read_b128 v[16:19], v10 offset:24576
    v_cvt_pk_bf16_f32 v51, v43, v47
    s_mov_b64 vcc, s[90:91]
    s_add_u32 s14, s50, 276480
    v_mfma_f32_16x16x32_bf16 v[36:39], v[20:23], v[148:151], v[36:39]
    s_setprio 0
    ds_read_b128 v[20:23], v11 offset:24576
    v_cndmask_b32_dpp v52, v50, v48, vcc row_ror:8 row_mask:0xf bank_mask:0xf
    s_waitcnt lgkmcnt(3)
    v_mfma_f32_16x16x32_bf16 v[36:39], v[28:31], v[164:167], v[36:39]
    v_cndmask_b32_dpp v53, v51, v49, vcc row_ror:8 row_mask:0xf bank_mask:0xf
    s_mov_b64 vcc, s[92:93]
    s_cmp_ge_u32 s14, s51
    s_cselect_b32 s49, s52, 0
    s_waitcnt lgkmcnt(2)
    v_mfma_f32_16x16x32_bf16 v[36:39], v[24:27], v[172:175], v[36:39]
    s_setprio 1
    v_cndmask_b32_dpp v54, v48, v50, vcc row_ror:8 row_mask:0xf bank_mask:0xf
    v_mfma_f32_16x16x32_bf16 v[32:35], v[24:27], v[168:171], v[32:35]
    ds_read_b128 v[24:27], v10 offset:28672
    v_cndmask_b32_dpp v55, v49, v51, vcc row_ror:8 row_mask:0xf bank_mask:0xf
    s_mov_b64 vcc, s[94:95]
    s_sub_u32 s14, s14, s49
    v_mfma_f32_16x16x32_bf16 v[32:35], v[28:31], v[160:163], v[32:35]
    s_setprio 0
    ds_read_b128 v[28:31], v11 offset:28672
    v_cndmask_b32_dpp v56, v53, v52, vcc row_ror:4 row_mask:0xf bank_mask:0xf
    s_waitcnt lgkmcnt(3)
    v_mfma_f32_16x16x32_bf16 v[32:35], v[16:19], v[176:179], v[32:35]
    v_cndmask_b32_dpp v58, v55, v54, vcc row_ror:4 row_mask:0xf bank_mask:0xf
    s_mov_b64 vcc, s[96:97]
    s_lshl_b32 s14, s14, 3
    s_waitcnt lgkmcnt(2)
    v_mfma_f32_16x16x32_bf16 v[32:35], v[20:23], v[184:187], v[32:35]
    s_setprio 1
    v_cndmask_b32_dpp v57, v52, v53, vcc row_ror:12 row_mask:0xf bank_mask:0xf
    v_mfma_f32_16x16x32_bf16 v[36:39], v[20:23], v[188:191], v[36:39]
    ds_read_b128 v[20:23], v10 offset:32768
    s_add_u32 m0, s54, 16384
    s_add_u32 s57, s69, s48
    buffer_load_dwordx4 v2, s[16:19], s57 offen lds
    v_cndmask_b32_dpp v59, v54, v55, vcc row_ror:12 row_mask:0xf bank_mask:0xf
    buffer_store_dwordx4 v[56:59], v3, s[32:35], s14 offen nt
    v_mfma_f32_16x16x32_bf16 v[36:39], v[16:19], v[180:183], v[36:39]
    s_setprio 0
    ds_read_b128 v[16:19], v11 offset:32768
    s_waitcnt lgkmcnt(3)
    v_mfma_f32_16x16x32_bf16 v[36:39], v[24:27], v[196:199], v[36:39]
    s_waitcnt lgkmcnt(2)
    v_mfma_f32_16x16x32_bf16 v[36:39], v[28:31], v[204:207], v[36:39]
    s_setprio 1
    v_mfma_f32_16x16x32_bf16 v[32:35], v[28:31], v[200:203], v[32:35]
    ds_read_b128 v[28:31], v8 offset:0
    v_mfma_f32_16x16x32_bf16 v[32:35], v[24:27], v[192:195], v[32:35]
    s_setprio 0
    ds_read_b128 v[24:27], v9 offset:0
    s_waitcnt lgkmcnt(3)
    v_mfma_f32_16x16x32_bf16 v[32:35], v[20:23], v[208:211], v[32:35]
    s_waitcnt lgkmcnt(2)
    v_mfma_f32_16x16x32_bf16 v[32:35], v[16:19], v[216:219], v[32:35]
    s_setprio 1
    v_mfma_f32_16x16x32_bf16 v[36:39], v[16:19], v[220:223], v[36:39]
    ds_read_b128 v[16:19], v8 offset:4096
    v_mfma_f32_16x16x32_bf16 v[36:39], v[20:23], v[212:215], v[36:39]
    s_setprio 0
    ds_read_b128 v[20:23], v9 offset:4096
    s_waitcnt lgkmcnt(3)
    v_mfma_f32_16x16x32_bf16 v[36:39], v[28:31], v[228:231], v[36:39]
    s_waitcnt lgkmcnt(2)
    v_mfma_f32_16x16x32_bf16 v[36:39], v[24:27], v[236:239], v[36:39]
    s_setprio 1
    s_waitcnt vmcnt(1)
    s_barrier
    s_setprio 1
    v_mfma_f32_16x16x32_bf16 v[32:35], v[24:27], v[232:235], v[32:35]
    v_mfma_f32_16x16x32_bf16 v[32:35], v[28:31], v[224:227], v[32:35]
    s_setprio 0
    s_waitcnt lgkmcnt(1)
    v_mfma_f32_16x16x32_bf16 v[32:35], v[16:19], v[240:243], v[32:35]
    s_waitcnt lgkmcnt(0)
    v_mfma_f32_16x16x32_bf16 v[32:35], v[20:23], v[248:251], v[32:35]
    s_setprio 1
    v_mfma_f32_16x16x32_bf16 v[36:39], v[20:23], v[252:255], v[36:39]
    v_mfma_f32_16x16x32_bf16 v[36:39], v[16:19], v[244:247], v[36:39]
    s_setprio 0
    s_nop 3
    s_nop 5
    v_cvt_pk_bf16_f32 v48, v32, v36
    v_cvt_pk_bf16_f32 v49, v33, v37
    v_cvt_pk_bf16_f32 v50, v34, v38
    v_cvt_pk_bf16_f32 v51, v35, v39
    s_mov_b64 vcc, s[90:91]
    s_add_u32 s14, s50, 313344
    v_cndmask_b32_dpp v52, v50, v48, vcc row_ror:8 row_mask:0xf bank_mask:0xf
    v_cndmask_b32_dpp v53, v51, v49, vcc row_ror:8 row_mask:0xf bank_mask:0xf
    s_mov_b64 vcc, s[92:93]
    s_cmp_ge_u32 s14, s51
    s_cselect_b32 s49, s52, 0
    v_cndmask_b32_dpp v54, v48, v50, vcc row_ror:8 row_mask:0xf bank_mask:0xf
    v_cndmask_b32_dpp v55, v49, v51, vcc row_ror:8 row_mask:0xf bank_mask:0xf
    s_mov_b64 vcc, s[94:95]
    s_sub_u32 s14, s14, s49
    v_cndmask_b32_dpp v56, v53, v52, vcc row_ror:4 row_mask:0xf bank_mask:0xf
    v_cndmask_b32_dpp v58, v55, v54, vcc row_ror:4 row_mask:0xf bank_mask:0xf
    s_mov_b64 vcc, s[96:97]
    s_lshl_b32 s14, s14, 3
    v_cndmask_b32_dpp v57, v52, v53, vcc row_ror:12 row_mask:0xf bank_mask:0xf
    v_cndmask_b32_dpp v59, v54, v55, vcc row_ror:12 row_mask:0xf bank_mask:0xf
    buffer_store_dwordx4 v[56:59], v3, s[32:35], s14 offen nt
    s_endpgm
L_done:
    s_endpgm
.section .rodata,"a"
.p2align 6
.amdhsa_kernel standalone__w4a16_gemm_dequant__prompt_kernel
  .amdhsa_next_free_vgpr 256
  .amdhsa_next_free_sgpr 102
  .amdhsa_accum_offset 256
  .amdhsa_group_segment_fixed_size 0
  .amdhsa_kernarg_size 56
  .amdhsa_user_sgpr_count 2
  .amdhsa_user_sgpr_kernarg_segment_ptr 1
  .amdhsa_system_sgpr_workgroup_id_x 1
.end_amdhsa_kernel
```
